```python
import torch

def _softmax(x, axis=-1):
    return torch.softmax(x, dim=axis)
def _gelu(x):
    return torch.nn.functional.gelu(x, approximate="tanh")
def _silu(x):
    return torch.nn.functional.silu(x)
def _sigmoid(x):
    return torch.sigmoid(x)
def _layernorm(x, axis=-1, eps=1e-5):
    m = x.mean(dim=axis, keepdim=True)
    v = x.var(dim=axis, keepdim=True, unbiased=False)
    return (x - m) / torch.sqrt(v + eps)
def _scatter_add(tgt, idx, src, axis=0):
    return tgt.clone().index_add_(axis, idx, src)
def _segment_sum(src, seg, n):
    out = torch.zeros((n,) + src.shape[1:], dtype=src.dtype)
    return out.index_add_(0, seg, src)
def _pad(x, pw):
    flat = tuple(v for pair in reversed(pw) for v in pair)
    return torch.nn.functional.pad(x, flat)

kernel_name = 'sequential_preLN__sliding_block_cached__glu_gated_bilinear__decode'

def setup_inputs():

    _w = (lambda a: (lambda t: t.to(torch.bfloat16) if t.is_floating_point() else t)(torch.as_tensor(a)))
    def _A_setup():
        B, Sq, D = 1, 1, 576
        Hq, Hkv, Sk, Dh = 32, 16, 65536, 128
        assert Hq % Hkv == 0, (Hq, Hkv)
        return {
            "x": _w((lambda *s: torch.randn(*s, dtype=torch.bfloat16) * 0.05)(B, Sq, D)),
            "k_cache": _w((lambda *s: torch.randn(*s, dtype=torch.bfloat16) * 1.6)(B, Hkv, Sk, Dh)),
            "v_cache": _w((lambda *s: torch.randn(*s, dtype=torch.bfloat16) * 0.8)(B, Hkv, Sk, Dh)),
            "wq": _w((lambda *s: torch.randn(*s, dtype=torch.bfloat16) * 1.6)(D, Hq * Dh) * (D ** -0.5)),
            "wo": _w((lambda *s: torch.randn(*s, dtype=torch.bfloat16) * 0.8)(Hq * Dh, D) * ((Hq * Dh) ** -0.5)),
        }
    _A_in = _A_setup()

    def _B_setup():
        B, S, D, F = 1, 1, 576, 4608
        return {
            "x": _w((lambda *s: torch.randn(*s, dtype=torch.bfloat16) * 0.05)(B, S, D)),
            "w_gate": _w((lambda *s: torch.randn(*s, dtype=torch.bfloat16) * 0.4)(D, F) * (D ** -0.5)),
            "w_up": _w((lambda *s: torch.randn(*s, dtype=torch.bfloat16) * 0.4)(D, F) * (D ** -0.5)),
            "w_down": _w((lambda *s: torch.randn(*s, dtype=torch.bfloat16) * 0.4)(F, D) * (F ** -0.5)),
        }
    _B_in = _B_setup()

    return {
        "A_x": _A_in["x"],
        "A_k_cache": _A_in["k_cache"],
        "A_v_cache": _A_in["v_cache"],
        "A_wq": _A_in["wq"],
        "A_wo": _A_in["wo"],
        "B_x": _B_in["x"],
        "B_w_gate": _B_in["w_gate"],
        "B_w_up": _B_in["w_up"],
        "B_w_down": _B_in["w_down"],
    }

def reference(A_x, A_k_cache, A_v_cache, A_wq, A_wo, B_x, B_w_gate, B_w_up, B_w_down):
    def _A_ref(x, k_cache, v_cache, wq, wo):
        B, Sq, D = x.shape
        Hq, Dh = 32, 128
        Hkv, Sk = k_cache.shape[1], k_cache.shape[2]
        W = min(4096, max(256, Sk // 4))
        rep = Hq // Hkv
        q = (lambda x, *d: x.permute(*d))((x @ wq).reshape(B, Sq, Hq, Dh), 0, 2, 1, 3)
        k = (lambda x, n, axis: torch.repeat_interleave(x, n, dim=axis))(k_cache[:, :, Sk - W:, :], rep, axis=1)
        v = (lambda x, n, axis: torch.repeat_interleave(x, n, dim=axis))(v_cache[:, :, Sk - W:, :], rep, axis=1)
        scores = torch.einsum("bhqd,bhkd->bhqk", q, k) * (Dh ** -0.5)
        p = _softmax(scores, axis=-1)
        o = torch.einsum("bhqk,bhkd->bhqd", p, v)
        return (lambda x, *d: x.permute(*d))(o, 0, 2, 1, 3).reshape(B, Sq, Hq * Dh) @ wo

    def _B_ref(x, w_gate, w_up, w_down):
        g = torch.einsum("bsd,df->bsf", x, w_gate)
        u = torch.einsum("bsd,df->bsf", x, w_up)
        h = g * u
        return torch.einsum("bsf,fd->bsd", h, w_down)

    x = A_x
    h = x + _A_ref(_layernorm(x, axis=-1), A_k_cache, A_v_cache, A_wq, A_wo)
    h2 = h + _B_ref(_layernorm(h, axis=-1), B_w_gate, B_w_up, B_w_down)
    return h2
```

```asm
; @launch grid=(256,1,1) block=(640,1,1) lds=24576
.amdgcn_target "amdgcn-amd-amdhsa--gfx950"
.text
.globl sequential_preLN__sliding_block_cached__glu_gated_bilinear__decode_kernel
.p2align 8
.type sequential_preLN__sliding_block_cached__glu_gated_bilinear__decode_kernel,@function
sequential_preLN__sliding_block_cached__glu_gated_bilinear__decode_kernel:
	s_cmp_ge_u32 s2, 256
	s_cbranch_scc1 L_end
	s_load_dwordx16 s[8:23], s[0:1], 0
	s_load_dwordx8 s[24:31], s[0:1], 64
	v_lshrrev_b32 v1, 6, v0
	v_and_b32 v0, 63, v0
	v_readfirstlane_b32 s3, v1
	s_and_b32 s4, s2, 7
	s_lshr_b32 s5, s2, 3
	s_and_b32 s7, s5, 1
	s_lshl_b32 s6, s4, 1
	s_or_b32 s7, s7, s6
	s_lshr_b32 s50, s5, 1
	s_add_u32 s6, s6, s50
	s_and_b32 s6, s6, 15
	s_cmp_eq_u32 s3, 9
	s_cbranch_scc1 L_ch
	s_cmp_eq_u32 s3, 8
	s_cbranch_scc1 L_auxpf
	v_bfe_u32 v4, v0, 2, 2
	v_lshlrev_b32 v4, 8, v4
	v_lshrrev_b32 v5, 4, v0
	v_lshl_add_u32 v4, v5, 6, v4
	v_and_b32 v5, 3, v0
	v_lshl_add_u32 v2, v5, 4, v4
	v_lshlrev_b32 v3, 4, v0
	s_and_b32 s50, s6, 1
	s_add_u32 s50, s50, s6
	s_add_u32 s50, s50, 6
	s_bfe_u32 s50, s50, 0x30001
	s_add_u32 s51, s50, 7
	s_and_b32 s51, s51, 7
	s_mov_b32 s52, 0
	s_cmp_lt_u32 s50, s4
	s_addc_u32 s52, s52, 0
	s_cmp_lt_u32 s51, s4
	s_addc_u32 s52, s52, 0
	s_lshl_b32 s52, s52, 1
	s_sub_u32 s50, s2, 144
	s_cmp_lt_u32 s50, 64
	s_cselect_b32 s53, 5, 9
	s_cselect_b32 s50, s7, 0
	s_and_b32 s50, s50, 1
	s_add_u32 s52, s52, s50
	s_lshl_b32 s52, s52, 15
	s_mul_i32 s55, s7, 73728
	s_sub_u32 s55, s55, s52
	s_lshl_b32 s50, s6, 24
	s_add_u32 s55, s55, s50
	s_mul_i32 s50, s3, s53
	s_lshl_b32 s50, s50, 10
	s_add_u32 s55, s55, s50
	s_add_u32 s55, s55, 0xF00000
	s_add_u32 s56, s55, 4096
	s_add_u32 s96, s55, 8192
	s_mov_b32 s63, s3
	s_waitcnt lgkmcnt(0)
	s_mov_b32 s32, s10
	s_and_b32 s33, s11, 0xffff
	s_mov_b32 s34, 0x10000000
	s_mov_b32 s35, 0x20000
	s_mov_b32 s36, s12
	s_and_b32 s37, s13, 0xffff
	s_mov_b32 s38, 0x10000000
	s_mov_b32 s39, 0x20000
	buffer_load_dwordx4 v[40:43], v2, s[32:35], s55 offen offset:0 nt
	buffer_load_dwordx4 v[44:47], v2, s[32:35], s55 offen offset:1024 nt
	buffer_load_dwordx4 v[48:51], v2, s[32:35], s55 offen offset:2048 nt
	s_barrier
	s_branch L_att2
L_auxpf:
	s_barrier
	s_cmp_ge_u32 s2, 248
	s_cbranch_scc0 L_aux
	s_getpc_b64 s[58:59]
L_pc:
	s_add_u32 s58, s58, L_att2-L_pc
	s_addc_u32 s59, s59, 0
	v_lshlrev_b32 v4, 4, v0
	global_load_dwordx4 v[40:43], v4, s[58:59] offset:0
	global_load_dwordx4 v[44:47], v4, s[58:59] offset:1024
	global_load_dwordx4 v[48:51], v4, s[58:59] offset:2048
	global_load_dwordx4 v[52:55], v4, s[58:59] offset:3072
	s_add_u32 s58, s58, 4096
	s_addc_u32 s59, s59, 0
	global_load_dwordx4 v[56:59], v4, s[58:59] offset:0
	global_load_dwordx4 v[60:63], v4, s[58:59] offset:1024
	global_load_dwordx4 v[64:67], v4, s[58:59] offset:2048
	global_load_dwordx4 v[68:71], v4, s[58:59] offset:3072
	s_add_u32 s58, s58, 4096
	s_addc_u32 s59, s59, 0
	global_load_dwordx4 v[72:75], v4, s[58:59] offset:0
	global_load_dwordx4 v[76:79], v4, s[58:59] offset:1024
	global_load_dwordx4 v[80:83], v4, s[58:59] offset:2048
	global_load_dwordx4 v[84:87], v4, s[58:59] offset:3072
	s_branch L_aux
L_ch:
	s_setprio 3
	v_lshlrev_b32 v2, 5, v0
	v_lshrrev_b32 v4, 4, v0
	v_bfe_u32 v3, v0, 3, 1
	v_lshl_add_u32 v3, v4, 1, v3
	v_lshlrev_b32 v3, 13, v3
	v_and_b32 v4, 7, v0
	v_lshl_add_u32 v3, v4, 4, v3
	s_and_b32 s68, s7, 3
	s_lshr_b32 s69, s7, 2
	s_mul_i32 s50, s68, 1179648
	s_lshl_b32 s51, s6, 9
	s_add_u32 s50, s50, s51
	s_lshl_b32 s51, s69, 7
	s_add_u32 s67, s50, s51
	s_waitcnt lgkmcnt(0)
	s_mov_b32 s44, s8
	s_and_b32 s45, s9, 0xffff
	s_mov_b32 s46, 0x480
	s_mov_b32 s47, 0x20000
	s_mov_b32 s32, s14
	s_and_b32 s33, s15, 0xffff
	s_mov_b32 s34, 0x480000
	s_mov_b32 s35, 0x20000
	s_mov_b32 s51, 65536
	buffer_load_dwordx4 v[40:43], v2, s[44:47], 0 offen
	buffer_load_dwordx4 v[44:47], v2, s[44:47], 0 offen offset:16
	buffer_load_dwordx4 v[64:67], v3, s[32:35], s67 offen nt
	s_add_u32 s67, s67, s51
	buffer_load_dwordx4 v[68:71], v3, s[32:35], s67 offen nt
	s_add_u32 s67, s67, s51
	buffer_load_dwordx4 v[72:75], v3, s[32:35], s67 offen nt
	s_add_u32 s67, s67, s51
	buffer_load_dwordx4 v[76:79], v3, s[32:35], s67 offen nt
	s_add_u32 s67, s67, s51
	buffer_load_dwordx4 v[80:83], v3, s[32:35], s67 offen nt
	s_add_u32 s67, s67, s51
	buffer_load_dwordx4 v[84:87], v3, s[32:35], s67 offen nt
	s_add_u32 s67, s67, s51
	buffer_load_dwordx4 v[88:91], v3, s[32:35], s67 offen nt
	s_add_u32 s67, s67, s51
	buffer_load_dwordx4 v[92:95], v3, s[32:35], s67 offen nt
	s_add_u32 s67, s67, s51
	buffer_load_dwordx4 v[96:99], v3, s[32:35], s67 offen nt
	s_add_u32 s67, s67, s51
	buffer_load_dwordx4 v[100:103], v3, s[32:35], s67 offen nt
	s_add_u32 s67, s67, s51
	buffer_load_dwordx4 v[104:107], v3, s[32:35], s67 offen nt
	s_add_u32 s67, s67, s51
	buffer_load_dwordx4 v[108:111], v3, s[32:35], s67 offen nt
	s_add_u32 s67, s67, s51
	buffer_load_dwordx4 v[112:115], v3, s[32:35], s67 offen nt
	s_add_u32 s67, s67, s51
	buffer_load_dwordx4 v[116:119], v3, s[32:35], s67 offen nt
	s_add_u32 s67, s67, s51
	buffer_load_dwordx4 v[120:123], v3, s[32:35], s67 offen nt
	s_add_u32 s67, s67, s51
	buffer_load_dwordx4 v[124:127], v3, s[32:35], s67 offen nt
	s_add_u32 s67, s67, s51
	buffer_load_dwordx4 v[128:131], v3, s[32:35], s67 offen nt
	s_add_u32 s67, s67, s51
	buffer_load_dwordx4 v[132:135], v3, s[32:35], s67 offen nt
	v_mov_b32 v4, 0
	v_mov_b32 v5, 0
	v_mov_b32 v6, 0
	ds_write_b64 v6, v[4:5] offset:800
	s_waitcnt lgkmcnt(0)
	s_barrier
	s_cmp_lt_u32 s2, 144
	s_cbranch_scc0 L1
	s_lshr_b32 s50, s5, 1
	s_mul_i32 s51, s4, 9
	s_add_u32 s50, s50, s51
	s_lshl_b32 s50, s50, 1
	s_and_b32 s51, s5, 1
	s_add_u32 s62, s50, s51
	s_branch L2
L1:
	s_sub_u32 s62, s2, 144
L2:
	s_mov_b32 s40, s30
	s_and_b32 s41, s31, 0xffff
	s_mov_b32 s42, 0x300000
	s_mov_b32 s43, 0x20000
	s_load_dword s66, s[30:31], 0x0
	v_and_b32 v4, 1, v0
	v_lshlrev_b32 v4, 4, v4
	v_mov_b32 v5, 0xffff
	v_lshlrev_b32 v4, v4, v5
	v_bfe_u32 v5, v0, 1, 2
	v_cmp_eq_u32 vcc, 0, v5
	s_nop 1
	v_cndmask_b32 v16, 0, v4, vcc
	v_cmp_eq_u32 vcc, 1, v5
	s_nop 1
	v_cndmask_b32 v17, 0, v4, vcc
	v_cmp_eq_u32 vcc, 2, v5
	s_nop 1
	v_cndmask_b32 v18, 0, v4, vcc
	v_cmp_eq_u32 vcc, 3, v5
	s_nop 1
	v_cndmask_b32 v19, 0, v4, vcc
	s_mul_i32 s50, s68, 9
	v_subrev_u32 v10, s50, v0
	v_cmp_gt_u32 vcc, 9, v10
	s_mov_b64 s[60:61], vcc
	v_lshlrev_b32 v10, 3, v10
	v_lshrrev_b32 v5, 4, v0
	v_bfe_u32 v11, v0, 3, 1
	v_lshl_add_u32 v11, v5, 1, v11
	v_mul_u32_u24 v11, 80, v11
	v_bfe_u32 v12, v0, 4, 1
	v_and_b32 v5, 7, v0
	v_lshl_add_u32 v12, v12, 3, v5
	v_lshlrev_b32 v12, 4, v12
	s_lshl_b32 s50, s6, 12
	s_add_u32 s67, s50, 0x1000
	s_lshl_b32 s51, s68, 10
	s_lshl_b32 s52, s69, 8
	s_add_u32 s51, s51, s52
	s_add_u32 s68, s51, s67
	v_lshlrev_b32 v13, 4, v0
	v_lshrrev_b32 v14, 3, v0
	v_lshlrev_b32 v14, 5, v14
	v_add_u32 v14, v14, v5
	v_lshlrev_b32 v14, 1, v14
	s_waitcnt lgkmcnt(0)
	s_add_u32 s48, s66, 1
	s_and_b32 s48, s48, 0xfff
	s_movk_i32 s49, 0xfff
	v_mov_b32 v1, s48
	s_waitcnt vmcnt(18)
	v_lshlrev_b32 v48, 16, v40
	v_and_b32 v49, 0xffff0000, v40
	v_lshlrev_b32 v50, 16, v41
	v_and_b32 v51, 0xffff0000, v41
	v_lshlrev_b32 v52, 16, v42
	v_and_b32 v53, 0xffff0000, v42
	v_lshlrev_b32 v54, 16, v43
	v_and_b32 v55, 0xffff0000, v43
	v_lshlrev_b32 v56, 16, v44
	v_and_b32 v57, 0xffff0000, v44
	v_lshlrev_b32 v58, 16, v45
	v_and_b32 v59, 0xffff0000, v45
	v_lshlrev_b32 v60, 16, v46
	v_and_b32 v61, 0xffff0000, v46
	v_lshlrev_b32 v62, 16, v47
	v_and_b32 v63, 0xffff0000, v47
	v_readfirstlane_b32 s53, v48
	v_cmp_gt_u32 vcc, 36, v0
	s_nop 0
	v_mov_b32 v6, s53
	v_cndmask_b32 v6, 0, v6, vcc
	v_sub_f32 v48, v48, v6
	v_sub_f32 v49, v49, v6
	v_sub_f32 v50, v50, v6
	v_sub_f32 v51, v51, v6
	v_sub_f32 v52, v52, v6
	v_sub_f32 v53, v53, v6
	v_sub_f32 v54, v54, v6
	v_sub_f32 v55, v55, v6
	v_sub_f32 v56, v56, v6
	v_sub_f32 v57, v57, v6
	v_sub_f32 v58, v58, v6
	v_sub_f32 v59, v59, v6
	v_sub_f32 v60, v60, v6
	v_sub_f32 v61, v61, v6
	v_sub_f32 v62, v62, v6
	v_sub_f32 v63, v63, v6
	v_add_f32 v4, v48, v49
	v_mul_f32 v5, v48, v48
	v_fmac_f32 v5, v49, v49
	v_add_f32 v7, v50, v51
	v_mul_f32 v8, v50, v50
	v_fmac_f32 v8, v51, v51
	v_add_f32 v4, v4, v52
	v_fmac_f32 v5, v52, v52
	v_add_f32 v7, v7, v53
	v_fmac_f32 v8, v53, v53
	v_add_f32 v4, v4, v54
	v_fmac_f32 v5, v54, v54
	v_add_f32 v7, v7, v55
	v_fmac_f32 v8, v55, v55
	v_add_f32 v4, v4, v56
	v_fmac_f32 v5, v56, v56
	v_add_f32 v7, v7, v57
	v_fmac_f32 v8, v57, v57
	v_add_f32 v4, v4, v58
	v_fmac_f32 v5, v58, v58
	v_add_f32 v7, v7, v59
	v_fmac_f32 v8, v59, v59
	v_add_f32 v4, v4, v60
	v_fmac_f32 v5, v60, v60
	v_add_f32 v7, v7, v61
	v_fmac_f32 v8, v61, v61
	v_add_f32 v4, v4, v62
	v_fmac_f32 v5, v62, v62
	v_add_f32 v7, v7, v63
	v_fmac_f32 v8, v63, v63
	v_add_f32 v4, v4, v7
	v_add_f32 v5, v5, v8
	s_nop 0
	v_add_f32_dpp v4, v4, v4 quad_perm:[1,0,3,2] row_mask:0xf bank_mask:0xf
	v_add_f32_dpp v5, v5, v5 quad_perm:[1,0,3,2] row_mask:0xf bank_mask:0xf
	s_nop 0
	v_add_f32_dpp v4, v4, v4 quad_perm:[2,3,0,1] row_mask:0xf bank_mask:0xf
	v_add_f32_dpp v5, v5, v5 quad_perm:[2,3,0,1] row_mask:0xf bank_mask:0xf
	s_nop 0
	v_add_f32_dpp v4, v4, v4 row_half_mirror row_mask:0xf bank_mask:0xf
	v_add_f32_dpp v5, v5, v5 row_half_mirror row_mask:0xf bank_mask:0xf
	s_nop 0
	v_add_f32_dpp v4, v4, v4 row_mirror row_mask:0xf bank_mask:0xf
	v_add_f32_dpp v5, v5, v5 row_mirror row_mask:0xf bank_mask:0xf
	v_mov_b32 v7, v4
	v_mov_b32 v8, v5
	s_nop 0
	v_permlane16_swap_b32 v7, v4
	v_permlane16_swap_b32 v8, v5
	v_add_f32 v4, v4, v7
	v_add_f32 v5, v5, v8
	v_mov_b32 v7, v4
	v_mov_b32 v8, v5
	s_nop 0
	v_permlane32_swap_b32 v7, v4
	v_permlane32_swap_b32 v8, v5
	v_add_f32 v4, v4, v7
	v_add_f32 v5, v5, v8
	s_mov_b32 s53, 0x3ae38e39
	v_mul_f32 v4, s53, v4
	v_mul_f32 v5, s53, v5
	v_fma_f32 v5, -v4, v4, v5
	v_max_f32 v5, 0, v5
	v_add_f32 v5, 0x3727c5ac, v5
	v_rsq_f32 v5, v5
	s_nop 0
	v_mul_f32 v4, v4, v5
	v_fma_f32 v48, v48, v5, -v4
	v_fma_f32 v49, v49, v5, -v4
	v_fma_f32 v50, v50, v5, -v4
	v_fma_f32 v51, v51, v5, -v4
	v_fma_f32 v52, v52, v5, -v4
	v_fma_f32 v53, v53, v5, -v4
	v_fma_f32 v54, v54, v5, -v4
	v_fma_f32 v55, v55, v5, -v4
	v_fma_f32 v56, v56, v5, -v4
	v_fma_f32 v57, v57, v5, -v4
	v_fma_f32 v58, v58, v5, -v4
	v_fma_f32 v59, v59, v5, -v4
	v_fma_f32 v60, v60, v5, -v4
	v_fma_f32 v61, v61, v5, -v4
	v_fma_f32 v62, v62, v5, -v4
	v_fma_f32 v63, v63, v5, -v4
	s_mov_b64 exec, s[60:61]
	v_cvt_pk_bf16_f32 v136, v48, v48
	v_cvt_pk_bf16_f32 v137, v56, v56
	ds_write_b64 v10, v[136:137] offset:10240
	v_cvt_pk_bf16_f32 v138, v49, v49
	v_cvt_pk_bf16_f32 v139, v57, v57
	ds_write_b64 v10, v[138:139] offset:10320
	v_cvt_pk_bf16_f32 v140, v50, v50
	v_cvt_pk_bf16_f32 v141, v58, v58
	ds_write_b64 v10, v[140:141] offset:10400
	v_cvt_pk_bf16_f32 v142, v51, v51
	v_cvt_pk_bf16_f32 v143, v59, v59
	ds_write_b64 v10, v[142:143] offset:10480
	v_cvt_pk_bf16_f32 v144, v52, v52
	v_cvt_pk_bf16_f32 v145, v60, v60
	ds_write_b64 v10, v[144:145] offset:10560
	v_cvt_pk_bf16_f32 v146, v53, v53
	v_cvt_pk_bf16_f32 v147, v61, v61
	ds_write_b64 v10, v[146:147] offset:10640
	v_cvt_pk_bf16_f32 v148, v54, v54
	v_cvt_pk_bf16_f32 v149, v62, v62
	ds_write_b64 v10, v[148:149] offset:10720
	v_cvt_pk_bf16_f32 v150, v55, v55
	v_cvt_pk_bf16_f32 v151, v63, v63
	ds_write_b64 v10, v[150:151] offset:10800
	s_mov_b64 exec, -1
	s_waitcnt lgkmcnt(0)
	ds_read_b128 v[136:139], v11 offset:10240
	ds_read_b128 v[140:143], v11 offset:10256
	ds_read_b128 v[144:147], v11 offset:10272
	ds_read_b128 v[148:151], v11 offset:10288
	ds_read_b128 v[152:155], v11 offset:10304
	s_waitcnt lgkmcnt(0)
	v_and_b32 v20, v136, v16
	v_and_b32 v21, v136, v17
	v_and_b32 v22, v136, v18
	v_and_b32 v23, v136, v19
	v_and_b32 v24, v137, v16
	v_and_b32 v25, v137, v17
	v_and_b32 v26, v137, v18
	v_and_b32 v27, v137, v19
	v_and_b32 v28, v138, v16
	v_and_b32 v29, v138, v17
	v_and_b32 v30, v138, v18
	v_and_b32 v31, v138, v19
	s_waitcnt vmcnt(17)
	v_mfma_f32_16x16x32_bf16 v[32:35], v[64:67], v[20:23], 0
	v_and_b32 v20, v139, v16
	v_and_b32 v21, v139, v17
	v_and_b32 v22, v139, v18
	v_and_b32 v23, v139, v19
	s_waitcnt vmcnt(16)
	v_mfma_f32_16x16x32_bf16 v[36:39], v[68:71], v[24:27], 0
	v_and_b32 v24, v140, v16
	v_and_b32 v25, v140, v17
	v_and_b32 v26, v140, v18
	v_and_b32 v27, v140, v19
	s_waitcnt vmcnt(15)
	v_mfma_f32_16x16x32_bf16 v[32:35], v[72:75], v[28:31], v[32:35]
	v_and_b32 v28, v141, v16
	v_and_b32 v29, v141, v17
	v_and_b32 v30, v141, v18
	v_and_b32 v31, v141, v19
	s_waitcnt vmcnt(14)
	v_mfma_f32_16x16x32_bf16 v[36:39], v[76:79], v[20:23], v[36:39]
	v_and_b32 v20, v142, v16
	v_and_b32 v21, v142, v17
	v_and_b32 v22, v142, v18
	v_and_b32 v23, v142, v19
	s_waitcnt vmcnt(13)
	v_mfma_f32_16x16x32_bf16 v[32:35], v[80:83], v[24:27], v[32:35]
	v_and_b32 v24, v143, v16
	v_and_b32 v25, v143, v17
	v_and_b32 v26, v143, v18
	v_and_b32 v27, v143, v19
	s_waitcnt vmcnt(12)
	v_mfma_f32_16x16x32_bf16 v[36:39], v[84:87], v[28:31], v[36:39]
	v_and_b32 v28, v144, v16
	v_and_b32 v29, v144, v17
	v_and_b32 v30, v144, v18
	v_and_b32 v31, v144, v19
	s_waitcnt vmcnt(11)
	v_mfma_f32_16x16x32_bf16 v[32:35], v[88:91], v[20:23], v[32:35]
	v_and_b32 v20, v145, v16
	v_and_b32 v21, v145, v17
	v_and_b32 v22, v145, v18
	v_and_b32 v23, v145, v19
	s_waitcnt vmcnt(10)
	v_mfma_f32_16x16x32_bf16 v[36:39], v[92:95], v[24:27], v[36:39]
	v_and_b32 v24, v146, v16
	v_and_b32 v25, v146, v17
	v_and_b32 v26, v146, v18
	v_and_b32 v27, v146, v19
	s_waitcnt vmcnt(9)
	v_mfma_f32_16x16x32_bf16 v[32:35], v[96:99], v[28:31], v[32:35]
	v_and_b32 v28, v147, v16
	v_and_b32 v29, v147, v17
	v_and_b32 v30, v147, v18
	v_and_b32 v31, v147, v19
	s_waitcnt vmcnt(8)
	v_mfma_f32_16x16x32_bf16 v[36:39], v[100:103], v[20:23], v[36:39]
	v_and_b32 v20, v148, v16
	v_and_b32 v21, v148, v17
	v_and_b32 v22, v148, v18
	v_and_b32 v23, v148, v19
	s_waitcnt vmcnt(7)
	v_mfma_f32_16x16x32_bf16 v[32:35], v[104:107], v[24:27], v[32:35]
	v_and_b32 v24, v149, v16
	v_and_b32 v25, v149, v17
	v_and_b32 v26, v149, v18
	v_and_b32 v27, v149, v19
	s_waitcnt vmcnt(6)
	v_mfma_f32_16x16x32_bf16 v[36:39], v[108:111], v[28:31], v[36:39]
	v_and_b32 v28, v150, v16
	v_and_b32 v29, v150, v17
	v_and_b32 v30, v150, v18
	v_and_b32 v31, v150, v19
	s_waitcnt vmcnt(5)
	v_mfma_f32_16x16x32_bf16 v[32:35], v[112:115], v[20:23], v[32:35]
	v_and_b32 v20, v151, v16
	v_and_b32 v21, v151, v17
	v_and_b32 v22, v151, v18
	v_and_b32 v23, v151, v19
	s_waitcnt vmcnt(4)
	v_mfma_f32_16x16x32_bf16 v[36:39], v[116:119], v[24:27], v[36:39]
	v_and_b32 v24, v152, v16
	v_and_b32 v25, v152, v17
	v_and_b32 v26, v152, v18
	v_and_b32 v27, v152, v19
	s_waitcnt vmcnt(3)
	v_mfma_f32_16x16x32_bf16 v[32:35], v[120:123], v[28:31], v[32:35]
	v_and_b32 v28, v153, v16
	v_and_b32 v29, v153, v17
	v_and_b32 v30, v153, v18
	v_and_b32 v31, v153, v19
	s_waitcnt vmcnt(2)
	v_mfma_f32_16x16x32_bf16 v[36:39], v[124:127], v[20:23], v[36:39]
	s_waitcnt vmcnt(1)
	v_mfma_f32_16x16x32_bf16 v[32:35], v[128:131], v[24:27], v[32:35]
	s_waitcnt vmcnt(0)
	v_mfma_f32_16x16x32_bf16 v[36:39], v[132:135], v[28:31], v[36:39]
	s_nop 7
	v_add_f32 v32, v32, v36
	v_add_f32 v33, v33, v37
	v_add_f32 v34, v34, v38
	v_add_f32 v35, v35, v39
	v_permlane32_swap_b32 v32, v20
	v_permlane32_swap_b32 v33, v21
	v_permlane32_swap_b32 v34, v22
	v_permlane32_swap_b32 v35, v23
	v_add_f32_dpp v32, v20, v32 row_ror:8 row_mask:0xf bank_mask:0xf
	v_add_f32_dpp v33, v21, v33 row_ror:8 row_mask:0xf bank_mask:0xf
	v_add_f32_dpp v34, v22, v34 row_ror:8 row_mask:0xf bank_mask:0xf
	v_add_f32_dpp v35, v23, v35 row_ror:8 row_mask:0xf bank_mask:0xf
	v_bfi_b32 v32, s49, v1, v32
	v_bfi_b32 v33, s49, v1, v33
	v_bfi_b32 v34, s49, v1, v34
	v_bfi_b32 v35, s49, v1, v35
	s_mov_b32 exec_lo, 0xff00ff
	s_mov_b32 exec_hi, 0x0
	buffer_store_dwordx4 v[32:35], v12, s[40:43], s68 offen sc1
	s_mov_b64 exec, -1
	s_mov_b32 s54, 0
	s_sleep 20
	buffer_load_dwordx4 v[64:67], v13, s[40:43], s67 offen offset:0 sc1
	buffer_load_dwordx4 v[68:71], v13, s[40:43], s67 offen offset:1024 sc1
	buffer_load_dwordx4 v[72:75], v13, s[40:43], s67 offen offset:2048 sc1
	buffer_load_dwordx4 v[76:79], v13, s[40:43], s67 offen offset:3072 sc1
Lp3:
	buffer_load_dwordx4 v[80:83], v13, s[40:43], s67 offen offset:0 sc1
	buffer_load_dwordx4 v[84:87], v13, s[40:43], s67 offen offset:1024 sc1
	buffer_load_dwordx4 v[88:91], v13, s[40:43], s67 offen offset:2048 sc1
	buffer_load_dwordx4 v[92:95], v13, s[40:43], s67 offen offset:3072 sc1
	s_waitcnt vmcnt(4)
	v_bitop3_b32 v5, v64, v65, v1 bitop3:0x7e
	v_bitop3_b32 v6, v66, v67, v1 bitop3:0x7e
	v_or_b32 v5, v5, v6
	v_bitop3_b32 v6, v68, v69, v1 bitop3:0x7e
	v_bitop3_b32 v7, v70, v71, v1 bitop3:0x7e
	v_or3_b32 v5, v5, v6, v7
	v_bitop3_b32 v6, v72, v73, v1 bitop3:0x7e
	v_bitop3_b32 v7, v74, v75, v1 bitop3:0x7e
	v_or3_b32 v5, v5, v6, v7
	v_bitop3_b32 v6, v76, v77, v1 bitop3:0x7e
	v_bitop3_b32 v7, v78, v79, v1 bitop3:0x7e
	v_or3_b32 v5, v5, v6, v7
	v_and_b32 v5, s49, v5
	v_cmp_ne_u32 vcc, 0, v5
	s_cbranch_vccz Lok4
	buffer_load_dwordx4 v[64:67], v13, s[40:43], s67 offen offset:0 sc1
	buffer_load_dwordx4 v[68:71], v13, s[40:43], s67 offen offset:1024 sc1
	buffer_load_dwordx4 v[72:75], v13, s[40:43], s67 offen offset:2048 sc1
	buffer_load_dwordx4 v[76:79], v13, s[40:43], s67 offen offset:3072 sc1
	s_waitcnt vmcnt(4)
	v_bitop3_b32 v5, v80, v81, v1 bitop3:0x7e
	v_bitop3_b32 v6, v82, v83, v1 bitop3:0x7e
	v_or_b32 v5, v5, v6
	v_bitop3_b32 v6, v84, v85, v1 bitop3:0x7e
	v_bitop3_b32 v7, v86, v87, v1 bitop3:0x7e
	v_or3_b32 v5, v5, v6, v7
	v_bitop3_b32 v6, v88, v89, v1 bitop3:0x7e
	v_bitop3_b32 v7, v90, v91, v1 bitop3:0x7e
	v_or3_b32 v5, v5, v6, v7
	v_bitop3_b32 v6, v92, v93, v1 bitop3:0x7e
	v_bitop3_b32 v7, v94, v95, v1 bitop3:0x7e
	v_or3_b32 v5, v5, v6, v7
	v_and_b32 v5, s49, v5
	v_cmp_ne_u32 vcc, 0, v5
	s_cbranch_vccz Lok5
	s_add_u32 s54, s54, 1
	s_cmp_lt_u32 s54, 200000
	s_cbranch_scc1 Lp3
Lok5:
	s_waitcnt vmcnt(0)
	v_mov_b32 v64, v80
	v_mov_b32 v65, v81
	v_mov_b32 v66, v82
	v_mov_b32 v67, v83
	v_mov_b32 v68, v84
	v_mov_b32 v69, v85
	v_mov_b32 v70, v86
	v_mov_b32 v71, v87
	v_mov_b32 v72, v88
	v_mov_b32 v73, v89
	v_mov_b32 v74, v90
	v_mov_b32 v75, v91
	v_mov_b32 v76, v92
	v_mov_b32 v77, v93
	v_mov_b32 v78, v94
	v_mov_b32 v79, v95
Lok4:
	v_add_f32 v64, v64, v68
	v_add_f32 v72, v72, v76
	v_add_f32 v65, v65, v69
	v_add_f32 v73, v73, v77
	v_add_f32 v66, v66, v70
	v_add_f32 v74, v74, v78
	v_add_f32 v67, v67, v71
	v_add_f32 v75, v75, v79
	v_add_f32 v64, v64, v72
	v_add_f32 v65, v65, v73
	v_add_f32 v66, v66, v74
	v_add_f32 v67, v67, v75
	v_cvt_pk_bf16_f32 v64, v64, v64
	v_cvt_pk_bf16_f32 v65, v65, v65
	v_cvt_pk_bf16_f32 v66, v66, v66
	v_cvt_pk_bf16_f32 v67, v67, v67
	ds_write_b16 v14, v64 offset:0
	ds_write_b16 v14, v65 offset:16
	ds_write_b16 v14, v66 offset:32
	ds_write_b16 v14, v67 offset:48
	v_mov_b32 v5, 1
	v_mov_b32 v6, 0
	s_waitcnt lgkmcnt(0)
	ds_write_b32 v6, v5 offset:800
	s_branch L_ch_roles
L_att2:
	s_cmp_lt_u32 s2, 144
	s_cbranch_scc0 L7
	s_lshr_b32 s50, s5, 1
	s_mul_i32 s51, s4, 9
	s_add_u32 s50, s50, s51
	s_lshl_b32 s50, s50, 1
	s_and_b32 s51, s5, 1
	s_add_u32 s62, s50, s51
	s_branch L8
L7:
	s_sub_u32 s62, s2, 144
L8:
	s_mov_b32 s40, s30
	s_and_b32 s41, s31, 0xffff
	s_mov_b32 s42, 0x300000
	s_mov_b32 s43, 0x20000
	s_load_dword s66, s[30:31], 0x0
	v_and_b32 v4, 1, v0
	v_lshlrev_b32 v4, 4, v4
	v_mov_b32 v5, 0xffff
	v_lshlrev_b32 v4, v4, v5
	v_bfe_u32 v5, v0, 1, 2
	v_cmp_eq_u32 vcc, 0, v5
	s_nop 1
	v_cndmask_b32 v12, 0, v4, vcc
	v_cmp_eq_u32 vcc, 1, v5
	s_nop 1
	v_cndmask_b32 v13, 0, v4, vcc
	v_cmp_eq_u32 vcc, 2, v5
	s_nop 1
	v_cndmask_b32 v14, 0, v4, vcc
	v_cmp_eq_u32 vcc, 3, v5
	s_nop 1
	v_cndmask_b32 v15, 0, v4, vcc
	s_mov_b32 s58, 0
	s_mov_b32 s59, 0
	s_mov_b32 s60, 0
	s_mov_b64 s[64:65], s[24:25]
	v_mov_b32 v36, 0
	v_mov_b32 v38, 0
	s_cmp_lt_u32 s2, 144
	s_cbranch_scc0 L9
	v_lshrrev_b32 v6, 4, v0
	v_bfe_u32 v4, v0, 3, 1
	v_lshl_add_u32 v4, v6, 1, v4
	s_movk_i32 s51, 9216
	v_mul_lo_u32 v36, v4, s51
	v_and_b32 v6, 7, v0
	v_lshl_add_u32 v36, v6, 4, v36
	s_and_b32 s50, s62, 1
	s_mul_i32 s50, s50, 288
	s_lshl_b32 s52, s63, 5
	s_add_u32 s50, s50, s52
	s_mul_i32 s50, s50, 9216
	s_lshr_b32 s52, s62, 1
	s_lshl_b32 s52, s52, 7
	s_add_u32 s50, s50, s52
	s_mov_b32 s58, s50
	s_mov_b32 s60, s50
	s_mov_b32 s59, 73728
	v_mul_u32_u24 v38, 1152, v4
	v_lshl_add_u32 v38, v6, 4, v38
	s_mul_i32 s50, s62, 36864
	s_lshl_b32 s51, s63, 7
	s_add_u32 s50, s50, s51
	s_add_u32 s64, s24, s50
	s_addc_u32 s65, s25, 0
	s_branch L10
L9:
	s_cmp_lt_u32 s2, 208
	s_cbranch_scc0 L10
	v_lshrrev_b32 v6, 4, v0
	v_bfe_u32 v4, v0, 3, 1
	v_lshl_add_u32 v4, v6, 1, v4
	v_mul_u32_u24 v38, 1152, v4
	v_and_b32 v6, 7, v0
	v_lshl_add_u32 v38, v6, 4, v38
	s_mul_i32 s50, s62, 73728
	s_lshl_b32 s51, s63, 7
	s_add_u32 s50, s50, s51
	s_add_u32 s64, s16, s50
	s_addc_u32 s65, s17, 0
L10:
	s_nop 1
	v_bfe_u32 v4, v0, 3, 1
	v_lshlrev_b32 v7, 5, v4
	s_lshl_b32 s50, s3, 2
	v_add_u32 v7, s50, v7
	v_lshlrev_b32 v4, 8, v4
	v_lshrrev_b32 v5, 4, v0
	v_lshl_add_u32 v4, v5, 6, v4
	v_and_b32 v5, 3, v0
	v_lshl_add_u32 v6, v5, 4, v4
	s_lshl_b32 s50, s3, 10
	v_add_u32 v8, s50, v3
	v_lshrrev_b32 v4, 3, v0
	s_and_b32 s50, s3, 1
	s_lshl_b32 s69, s50, 5
	v_lshlrev_b32 v10, 2, v4
	v_add_u32 v10, s69, v10
	v_lshlrev_b32 v4, 10, v4
	v_and_b32 v5, 7, v0
	v_lshlrev_b32 v11, 4, v5
	v_add_u32 v4, v4, v11
	s_lshl_b32 s51, s3, 7
	v_add_u32 v9, s51, v4
	s_lshl_b32 s51, s50, 1
	s_lshr_b32 s52, s3, 2
	s_add_u32 s51, s51, s52
	s_lshl_b32 s52, s6, 2
	s_add_u32 s51, s51, s52
	s_mul_i32 s51, s51, 6144
	s_mul_i32 s52, s7, 384
	s_add_u32 s51, s51, s52
	s_add_u32 s67, s51, 0x20000
	s_bfe_u32 s52, s3, 0x10001
	s_lshl_b32 s52, s52, 7
	s_add_u32 s68, s67, s52
	s_mov_b32 s57, 0x3e0293ee
	v_mov_b32 v37, s69
	s_waitcnt lgkmcnt(0)
	s_add_u32 s48, s66, 1
	s_and_b32 s48, s48, 0xfff
	s_movk_i32 s49, 0xfff
	v_mov_b32 v1, s48
	s_sub_u32 s50, s2, 144
	s_cmp_lt_u32 s50, 64
	s_cbranch_scc1 L_att_WO
	s_waitcnt vmcnt(2)
	buffer_load_dwordx4 v[52:55], v2, s[32:35], s55 offen offset:3072 nt
	s_waitcnt vmcnt(2)
	buffer_load_dwordx4 v[56:59], v2, s[32:35], s56 offen offset:0 nt
	s_waitcnt vmcnt(2)
	buffer_load_dwordx4 v[60:63], v2, s[32:35], s56 offen offset:1024 nt
	s_waitcnt vmcnt(2)
	buffer_load_dwordx4 v[64:67], v2, s[32:35], s56 offen offset:2048 nt
	s_waitcnt vmcnt(2)
	buffer_load_dwordx4 v[68:71], v2, s[32:35], s56 offen offset:3072 nt
	s_waitcnt vmcnt(2)
	buffer_load_dwordx4 v[72:75], v2, s[32:35], s96 offen offset:0 nt
	buffer_load_dwordx4 v[76:79], v3, s[36:39], s55 offen offset:0 nt
	s_waitcnt vmcnt(3)
	buffer_load_dwordx4 v[80:83], v3, s[36:39], s55 offen offset:1024 nt
	s_waitcnt vmcnt(3)
	buffer_load_dwordx4 v[84:87], v3, s[36:39], s55 offen offset:2048 nt
	s_waitcnt vmcnt(3)
	buffer_load_dwordx4 v[88:91], v3, s[36:39], s55 offen offset:3072 nt
	s_waitcnt vmcnt(3)
	buffer_load_dwordx4 v[92:95], v3, s[36:39], s56 offen offset:0 nt
	s_waitcnt vmcnt(3)
	buffer_load_dwordx4 v[96:99], v3, s[36:39], s56 offen offset:1024 nt
	s_waitcnt vmcnt(3)
	buffer_load_dwordx4 v[100:103], v3, s[36:39], s56 offen offset:2048 nt
	s_waitcnt vmcnt(3)
	buffer_load_dwordx4 v[104:107], v3, s[36:39], s56 offen offset:3072 nt
	s_waitcnt vmcnt(3)
	buffer_load_dwordx4 v[108:111], v3, s[36:39], s96 offen offset:0 nt
	v_mov_b32 v4, 0
Lw11:
	ds_read_b32 v5, v4 offset:800
	ds_read_b128 v[16:19], v6 offset:0
	s_waitcnt lgkmcnt(0)
	v_readfirstlane_b32 s54, v5
	s_cmp_lg_u32 s54, 1
	s_cbranch_scc1 Lw11
	v_mfma_f32_16x16x32_bf16 v[112:115], v[40:43], v[16:19], 0
	v_mfma_f32_16x16x32_bf16 v[116:119], v[44:47], v[16:19], 0
	v_mfma_f32_16x16x32_bf16 v[120:123], v[48:51], v[16:19], 0
	v_mfma_f32_16x16x32_bf16 v[124:127], v[52:55], v[16:19], 0
	v_mfma_f32_16x16x32_bf16 v[128:131], v[56:59], v[16:19], 0
	v_mfma_f32_16x16x32_bf16 v[132:135], v[60:63], v[16:19], 0
	v_mfma_f32_16x16x32_bf16 v[136:139], v[64:67], v[16:19], 0
	v_mfma_f32_16x16x32_bf16 v[140:143], v[68:71], v[16:19], 0
	v_mfma_f32_16x16x32_bf16 v[144:147], v[72:75], v[16:19], 0
	v_mov_b32_dpp v112, v112 quad_perm:[0,0,0,0] row_mask:0xf bank_mask:0xf
	v_mov_b32_dpp v116, v116 quad_perm:[0,0,0,0] row_mask:0xf bank_mask:0xf
	v_mov_b32_dpp v120, v120 quad_perm:[0,0,0,0] row_mask:0xf bank_mask:0xf
	v_mov_b32_dpp v124, v124 quad_perm:[0,0,0,0] row_mask:0xf bank_mask:0xf
	v_mov_b32_dpp v128, v128 quad_perm:[0,0,0,0] row_mask:0xf bank_mask:0xf
	v_mov_b32_dpp v132, v132 quad_perm:[0,0,0,0] row_mask:0xf bank_mask:0xf
	v_mov_b32_dpp v136, v136 quad_perm:[0,0,0,0] row_mask:0xf bank_mask:0xf
	v_mov_b32_dpp v140, v140 quad_perm:[0,0,0,0] row_mask:0xf bank_mask:0xf
	v_mov_b32_dpp v144, v144 quad_perm:[0,0,0,0] row_mask:0xf bank_mask:0xf
	v_add_f32_dpp v112, v113, v112 quad_perm:[1,1,1,1] row_mask:0xf bank_mask:0xf
	v_add_f32_dpp v116, v117, v116 quad_perm:[1,1,1,1] row_mask:0xf bank_mask:0xf
	v_add_f32_dpp v120, v121, v120 quad_perm:[1,1,1,1] row_mask:0xf bank_mask:0xf
	v_add_f32_dpp v124, v125, v124 quad_perm:[1,1,1,1] row_mask:0xf bank_mask:0xf
	v_add_f32_dpp v128, v129, v128 quad_perm:[1,1,1,1] row_mask:0xf bank_mask:0xf
	v_add_f32_dpp v132, v133, v132 quad_perm:[1,1,1,1] row_mask:0xf bank_mask:0xf
	v_add_f32_dpp v136, v137, v136 quad_perm:[1,1,1,1] row_mask:0xf bank_mask:0xf
	v_add_f32_dpp v140, v141, v140 quad_perm:[1,1,1,1] row_mask:0xf bank_mask:0xf
	v_add_f32_dpp v144, v145, v144 quad_perm:[1,1,1,1] row_mask:0xf bank_mask:0xf
	v_add_f32_dpp v112, v114, v112 quad_perm:[2,2,2,2] row_mask:0xf bank_mask:0xf
	v_add_f32_dpp v116, v118, v116 quad_perm:[2,2,2,2] row_mask:0xf bank_mask:0xf
	v_add_f32_dpp v120, v122, v120 quad_perm:[2,2,2,2] row_mask:0xf bank_mask:0xf
	v_add_f32_dpp v124, v126, v124 quad_perm:[2,2,2,2] row_mask:0xf bank_mask:0xf
	v_add_f32_dpp v128, v130, v128 quad_perm:[2,2,2,2] row_mask:0xf bank_mask:0xf
	v_add_f32_dpp v132, v134, v132 quad_perm:[2,2,2,2] row_mask:0xf bank_mask:0xf
	v_add_f32_dpp v136, v138, v136 quad_perm:[2,2,2,2] row_mask:0xf bank_mask:0xf
	v_add_f32_dpp v140, v142, v140 quad_perm:[2,2,2,2] row_mask:0xf bank_mask:0xf
	v_add_f32_dpp v144, v146, v144 quad_perm:[2,2,2,2] row_mask:0xf bank_mask:0xf
	v_add_f32_dpp v112, v115, v112 quad_perm:[3,3,3,3] row_mask:0xf bank_mask:0xf
	v_add_f32_dpp v116, v119, v116 quad_perm:[3,3,3,3] row_mask:0xf bank_mask:0xf
	v_add_f32_dpp v120, v123, v120 quad_perm:[3,3,3,3] row_mask:0xf bank_mask:0xf
	v_add_f32_dpp v124, v127, v124 quad_perm:[3,3,3,3] row_mask:0xf bank_mask:0xf
	v_add_f32_dpp v128, v131, v128 quad_perm:[3,3,3,3] row_mask:0xf bank_mask:0xf
	v_add_f32_dpp v132, v135, v132 quad_perm:[3,3,3,3] row_mask:0xf bank_mask:0xf
	v_add_f32_dpp v136, v139, v136 quad_perm:[3,3,3,3] row_mask:0xf bank_mask:0xf
	v_add_f32_dpp v140, v143, v140 quad_perm:[3,3,3,3] row_mask:0xf bank_mask:0xf
	v_add_f32_dpp v144, v147, v144 quad_perm:[3,3,3,3] row_mask:0xf bank_mask:0xf
	v_max3_f32 v39, v112, v116, v120
	v_max3_f32 v4, v124, v128, v132
	v_max3_f32 v39, v39, v136, v140
	v_max3_f32 v39, v39, v144, v4
	v_mov_b32 v4, v39
	s_nop 1
	v_permlane16_swap_b32 v4, v39
	v_max_f32 v39, v39, v4
	v_mov_b32 v4, v39
	s_nop 1
	v_permlane32_swap_b32 v4, v39
	v_max_f32 v39, v39, v4
	v_mul_f32 v39, s57, v39
	v_fma_f32 v112, v112, s57, -v39
	v_fma_f32 v116, v116, s57, -v39
	v_fma_f32 v120, v120, s57, -v39
	v_fma_f32 v124, v124, s57, -v39
	v_fma_f32 v128, v128, s57, -v39
	v_fma_f32 v132, v132, s57, -v39
	v_fma_f32 v136, v136, s57, -v39
	v_fma_f32 v140, v140, s57, -v39
	v_fma_f32 v144, v144, s57, -v39
	v_exp_f32 v112, v112
	v_exp_f32 v116, v116
	v_exp_f32 v120, v120
	v_exp_f32 v124, v124
	v_exp_f32 v128, v128
	v_exp_f32 v132, v132
	v_exp_f32 v136, v136
	v_exp_f32 v140, v140
	v_exp_f32 v144, v144
	v_cvt_pk_bf16_f32 v113, v112, v112
	v_cvt_pk_bf16_f32 v117, v116, v116
	v_cvt_pk_bf16_f32 v121, v120, v120
	v_cvt_pk_bf16_f32 v125, v124, v124
	v_cvt_pk_bf16_f32 v129, v128, v128
	v_cvt_pk_bf16_f32 v133, v132, v132
	v_cvt_pk_bf16_f32 v137, v136, v136
	v_cvt_pk_bf16_f32 v141, v140, v140
	v_cvt_pk_bf16_f32 v145, v144, v144
	s_mov_b32 s32, s20
	s_and_b32 s33, s21, 0xffff
	s_mov_b32 s34, 0x510000
	s_mov_b32 s35, 0x20000
	s_mov_b32 s36, s22
	s_and_b32 s37, s23, 0xffff
	s_mov_b32 s38, 0x510000
	s_mov_b32 s39, 0x20000
	s_cmp_lt_u32 s2, 144
	s_cselect_b32 s34, s34, 0
	s_cselect_b32 s38, s38, 0
	buffer_load_dwordx4 v[40:43], v36, s[32:35], s58 offen nt
	s_add_u32 s58, s58, s59
	buffer_load_dwordx4 v[56:59], v36, s[36:39], s60 offen nt
	s_add_u32 s60, s60, s59
	v_and_b32 v20, v113, v12
	v_and_b32 v21, v113, v13
	v_and_b32 v22, v113, v14
	v_and_b32 v23, v113, v15
	v_and_b32 v24, v117, v12
	v_and_b32 v25, v117, v13
	v_and_b32 v26, v117, v14
	v_and_b32 v27, v117, v15
	v_and_b32 v16, v121, v12
	v_and_b32 v17, v121, v13
	v_and_b32 v18, v121, v14
	v_and_b32 v19, v121, v15
	v_mfma_f32_16x16x32_bf16 v[28:31], v[76:79], v[20:23], 0
	v_and_b32 v20, v125, v12
	v_and_b32 v21, v125, v13
	v_and_b32 v22, v125, v14
	v_and_b32 v23, v125, v15
	v_mfma_f32_16x16x32_bf16 v[32:35], v[80:83], v[24:27], 0
	v_and_b32 v24, v129, v12
	v_and_b32 v25, v129, v13
	v_and_b32 v26, v129, v14
	v_and_b32 v27, v129, v15
	v_mfma_f32_16x16x32_bf16 v[28:31], v[84:87], v[16:19], v[28:31]
	v_and_b32 v16, v133, v12
	v_and_b32 v17, v133, v13
	v_and_b32 v18, v133, v14
	v_and_b32 v19, v133, v15
	v_mfma_f32_16x16x32_bf16 v[32:35], v[88:91], v[20:23], v[32:35]
	v_and_b32 v20, v137, v12
	v_and_b32 v21, v137, v13
	v_and_b32 v22, v137, v14
	v_and_b32 v23, v137, v15
	v_mfma_f32_16x16x32_bf16 v[28:31], v[92:95], v[24:27], v[28:31]
	v_and_b32 v24, v141, v12
	v_and_b32 v25, v141, v13
	v_and_b32 v26, v141, v14
	v_and_b32 v27, v141, v15
	s_waitcnt vmcnt(5)
	v_mfma_f32_16x16x32_bf16 v[32:35], v[96:99], v[16:19], v[32:35]
	v_and_b32 v16, v145, v12
	v_and_b32 v17, v145, v13
	v_and_b32 v18, v145, v14
	v_and_b32 v19, v145, v15
	s_waitcnt vmcnt(4)
	v_mfma_f32_16x16x32_bf16 v[28:31], v[100:103], v[20:23], v[28:31]
	s_waitcnt vmcnt(3)
	v_mfma_f32_16x16x32_bf16 v[32:35], v[104:107], v[24:27], v[32:35]
	s_waitcnt vmcnt(2)
	v_mfma_f32_16x16x32_bf16 v[28:31], v[108:111], v[16:19], v[28:31]
	v_add_f32 v112, v112, v116
	v_add_f32 v120, v120, v124
	v_add_f32 v128, v128, v132
	v_add_f32 v136, v136, v140
	v_add_f32 v112, v112, v120
	v_add_f32 v128, v128, v136
	v_add_f32 v112, v112, v128
	v_add_f32 v112, v112, v144
	s_nop 1
	v_permlane32_swap_b32 v112, v4
	v_add_f32 v112, v112, v4
	s_nop 1
	v_permlane16_swap_b32 v112, v4
	v_add_f32 v112, v112, v4
	v_add_f32 v28, v28, v32
	v_add_f32 v29, v29, v33
	v_add_f32 v30, v30, v34
	v_add_f32 v31, v31, v35
	ds_write_b128 v8, v[28:31] offset:1024
	s_mov_b32 exec_lo, 0x101
	s_mov_b32 exec_hi, 0x0
	ds_write_b32 v7, v39 offset:512
	ds_write_b32 v7, v112 offset:640
	s_mov_b32 exec_lo, 0x1
	s_mov_b32 exec_hi, 0x0
	v_mov_b32 v4, 0
	v_mov_b32 v5, 1
	ds_add_u32 v4, v5 offset:804
	s_mov_b64 exec, -1
	s_branch L_att_pub
L_att_WO:
	s_waitcnt vmcnt(2)
	buffer_load_dwordx4 v[52:55], v2, s[32:35], s55 offen offset:3072 nt
	s_waitcnt vmcnt(2)
	buffer_load_dwordx4 v[56:59], v2, s[32:35], s56 offen offset:0 nt
	buffer_load_dwordx4 v[60:63], v3, s[36:39], s55 offen offset:0 nt
	s_waitcnt vmcnt(3)
	buffer_load_dwordx4 v[64:67], v3, s[36:39], s55 offen offset:1024 nt
	s_waitcnt vmcnt(3)
	buffer_load_dwordx4 v[68:71], v3, s[36:39], s55 offen offset:2048 nt
	s_waitcnt vmcnt(3)
	buffer_load_dwordx4 v[72:75], v3, s[36:39], s55 offen offset:3072 nt
	s_waitcnt vmcnt(3)
	buffer_load_dwordx4 v[76:79], v3, s[36:39], s56 offen offset:0 nt
	s_waitcnt vmcnt(3)
	global_load_dwordx4 v[120:123], v38, s[64:65] nt
	s_add_u32 s64, s64, 9216
	s_addc_u32 s65, s65, 0
	s_waitcnt vmcnt(3)
	global_load_dwordx4 v[124:127], v38, s[64:65] nt
	s_add_u32 s64, s64, 9216
	s_addc_u32 s65, s65, 0
	s_waitcnt vmcnt(3)
	global_load_dwordx4 v[128:131], v38, s[64:65] nt
	s_add_u32 s64, s64, 9216
	s_addc_u32 s65, s65, 0
	s_waitcnt vmcnt(3)
	global_load_dwordx4 v[132:135], v38, s[64:65] nt
	s_add_u32 s64, s64, 9216
	s_addc_u32 s65, s65, 0
	s_waitcnt vmcnt(3)
	global_load_dwordx4 v[136:139], v38, s[64:65] nt
	s_add_u32 s64, s64, 9216
	s_addc_u32 s65, s65, 0
	s_waitcnt vmcnt(3)
	global_load_dwordx4 v[140:143], v38, s[64:65] nt
	s_add_u32 s64, s64, 9216
	s_addc_u32 s65, s65, 0
	s_waitcnt vmcnt(3)
	global_load_dwordx4 v[144:147], v38, s[64:65] nt
	s_add_u32 s64, s64, 9216
	s_addc_u32 s65, s65, 0
	s_waitcnt vmcnt(3)
	global_load_dwordx4 v[148:151], v38, s[64:65] nt
	v_mov_b32 v4, 0
Lw12:
	ds_read_b32 v5, v4 offset:800
	ds_read_b128 v[16:19], v6 offset:0
	s_waitcnt lgkmcnt(0)
	v_readfirstlane_b32 s54, v5
	s_cmp_lg_u32 s54, 1
	s_cbranch_scc1 Lw12
	v_mfma_f32_16x16x32_bf16 v[80:83], v[40:43], v[16:19], 0
	v_mfma_f32_16x16x32_bf16 v[84:87], v[44:47], v[16:19], 0
	v_mfma_f32_16x16x32_bf16 v[88:91], v[48:51], v[16:19], 0
	v_mfma_f32_16x16x32_bf16 v[92:95], v[52:55], v[16:19], 0
	v_mfma_f32_16x16x32_bf16 v[96:99], v[56:59], v[16:19], 0
	s_nop 3
	v_mov_b32_dpp v80, v80 quad_perm:[0,0,0,0] row_mask:0xf bank_mask:0xf
	v_mov_b32_dpp v84, v84 quad_perm:[0,0,0,0] row_mask:0xf bank_mask:0xf
	v_mov_b32_dpp v88, v88 quad_perm:[0,0,0,0] row_mask:0xf bank_mask:0xf
	v_mov_b32_dpp v92, v92 quad_perm:[0,0,0,0] row_mask:0xf bank_mask:0xf
	v_mov_b32_dpp v96, v96 quad_perm:[0,0,0,0] row_mask:0xf bank_mask:0xf
	v_add_f32_dpp v80, v81, v80 quad_perm:[1,1,1,1] row_mask:0xf bank_mask:0xf
	v_add_f32_dpp v84, v85, v84 quad_perm:[1,1,1,1] row_mask:0xf bank_mask:0xf
	v_add_f32_dpp v88, v89, v88 quad_perm:[1,1,1,1] row_mask:0xf bank_mask:0xf
	v_add_f32_dpp v92, v93, v92 quad_perm:[1,1,1,1] row_mask:0xf bank_mask:0xf
	v_add_f32_dpp v96, v97, v96 quad_perm:[1,1,1,1] row_mask:0xf bank_mask:0xf
	v_add_f32_dpp v80, v82, v80 quad_perm:[2,2,2,2] row_mask:0xf bank_mask:0xf
	v_add_f32_dpp v84, v86, v84 quad_perm:[2,2,2,2] row_mask:0xf bank_mask:0xf
	v_add_f32_dpp v88, v90, v88 quad_perm:[2,2,2,2] row_mask:0xf bank_mask:0xf
	v_add_f32_dpp v92, v94, v92 quad_perm:[2,2,2,2] row_mask:0xf bank_mask:0xf
	v_add_f32_dpp v96, v98, v96 quad_perm:[2,2,2,2] row_mask:0xf bank_mask:0xf
	v_add_f32_dpp v80, v83, v80 quad_perm:[3,3,3,3] row_mask:0xf bank_mask:0xf
	v_add_f32_dpp v84, v87, v84 quad_perm:[3,3,3,3] row_mask:0xf bank_mask:0xf
	v_add_f32_dpp v88, v91, v88 quad_perm:[3,3,3,3] row_mask:0xf bank_mask:0xf
	v_add_f32_dpp v92, v95, v92 quad_perm:[3,3,3,3] row_mask:0xf bank_mask:0xf
	v_add_f32_dpp v96, v99, v96 quad_perm:[3,3,3,3] row_mask:0xf bank_mask:0xf
	v_max3_f32 v39, v80, v84, v88
	v_max3_f32 v39, v39, v92, v96
	v_mov_b32 v4, v39
	s_nop 1
	v_permlane16_swap_b32 v4, v39
	v_max_f32 v39, v39, v4
	v_mov_b32 v4, v39
	s_nop 1
	v_permlane32_swap_b32 v4, v39
	v_max_f32 v39, v39, v4
	v_mul_f32 v39, s57, v39
	v_fma_f32 v80, v80, s57, -v39
	v_fma_f32 v84, v84, s57, -v39
	v_fma_f32 v88, v88, s57, -v39
	v_fma_f32 v92, v92, s57, -v39
	v_fma_f32 v96, v96, s57, -v39
	v_exp_f32 v80, v80
	v_exp_f32 v84, v84
	v_exp_f32 v88, v88
	v_exp_f32 v92, v92
	v_exp_f32 v96, v96
	v_cvt_pk_bf16_f32 v81, v80, v80
	v_cvt_pk_bf16_f32 v85, v84, v84
	v_cvt_pk_bf16_f32 v89, v88, v88
	v_cvt_pk_bf16_f32 v93, v92, v92
	v_cvt_pk_bf16_f32 v97, v96, v96
	v_and_b32 v20, v81, v12
	v_and_b32 v21, v81, v13
	v_and_b32 v22, v81, v14
	v_and_b32 v23, v81, v15
	v_and_b32 v24, v85, v12
	v_and_b32 v25, v85, v13
	v_and_b32 v26, v85, v14
	v_and_b32 v27, v85, v15
	v_and_b32 v16, v89, v12
	v_and_b32 v17, v89, v13
	v_and_b32 v18, v89, v14
	v_and_b32 v19, v89, v15
	v_mfma_f32_16x16x32_bf16 v[28:31], v[60:63], v[20:23], 0
	v_and_b32 v20, v93, v12
	v_and_b32 v21, v93, v13
	v_and_b32 v22, v93, v14
	v_and_b32 v23, v93, v15
	v_mfma_f32_16x16x32_bf16 v[32:35], v[64:67], v[24:27], 0
	v_and_b32 v24, v97, v12
	v_and_b32 v25, v97, v13
	v_and_b32 v26, v97, v14
	v_and_b32 v27, v97, v15
	v_mfma_f32_16x16x32_bf16 v[28:31], v[68:71], v[16:19], v[28:31]
	v_mfma_f32_16x16x32_bf16 v[32:35], v[72:75], v[20:23], v[32:35]
	v_mfma_f32_16x16x32_bf16 v[28:31], v[76:79], v[24:27], v[28:31]
	v_add_f32 v80, v80, v84
	v_add_f32 v88, v88, v92
	v_add_f32 v80, v80, v88
	v_add_f32 v80, v80, v96
	s_nop 1
	v_permlane32_swap_b32 v80, v4
	v_add_f32 v80, v80, v4
	s_nop 1
	v_permlane16_swap_b32 v80, v4
	v_add_f32 v80, v80, v4
	v_add_f32 v28, v28, v32
	v_add_f32 v29, v29, v33
	v_add_f32 v30, v30, v34
	v_add_f32 v31, v31, v35
	ds_write_b128 v8, v[28:31] offset:1024
	s_mov_b32 exec_lo, 0x101
	s_mov_b32 exec_hi, 0x0
	ds_write_b32 v7, v39 offset:512
	ds_write_b32 v7, v80 offset:640
	s_mov_b32 exec_lo, 0x1
	s_mov_b32 exec_hi, 0x0
	v_mov_b32 v4, 0
	v_mov_b32 v5, 1
	ds_add_u32 v4, v5 offset:804
	s_mov_b64 exec, -1
L_att_pub:
	v_mov_b32 v4, 0
Lw13:
	ds_read_b32 v5, v4 offset:804
	ds_read_b128 v[152:155], v9 offset:1024
	ds_read_b32 v157, v10 offset:512
	ds_read_b32 v156, v10 offset:640
	ds_read_b128 v[20:23], v37 offset:512
	ds_read_b128 v[24:27], v37 offset:528
	s_waitcnt lgkmcnt(0)
	v_readfirstlane_b32 s54, v5
	s_cmp_lg_u32 s54, 8
	s_cbranch_scc1 Lw13
	v_max3_f32 v39, v20, v21, v22
	v_max3_f32 v5, v23, v24, v25
	v_max3_f32 v39, v39, v26, v27
	v_max_f32 v39, v39, v5
	v_sub_f32 v157, v157, v39
	v_exp_f32 v157, v157
	s_nop 0
	v_mul_f32 v152, v152, v157
	v_mul_f32 v153, v153, v157
	v_mul_f32 v154, v154, v157
	v_mul_f32 v155, v155, v157
	v_mul_f32 v156, v156, v157
	v_add_f32_dpp v152, v152, v152 row_ror:8 row_mask:0xf bank_mask:0xf
	v_add_f32_dpp v153, v153, v153 row_ror:8 row_mask:0xf bank_mask:0xf
	v_add_f32_dpp v154, v154, v154 row_ror:8 row_mask:0xf bank_mask:0xf
	v_add_f32_dpp v155, v155, v155 row_ror:8 row_mask:0xf bank_mask:0xf
	v_add_f32_dpp v156, v156, v156 row_ror:8 row_mask:0xf bank_mask:0xf
	v_permlane32_swap_b32 v152, v20
	v_permlane32_swap_b32 v153, v21
	v_permlane32_swap_b32 v154, v22
	v_permlane32_swap_b32 v155, v23
	v_permlane32_swap_b32 v156, v24
	v_add_f32 v152, v152, v20
	v_add_f32 v153, v153, v21
	v_add_f32 v154, v154, v22
	v_add_f32 v155, v155, v23
	v_add_f32 v156, v156, v24
	v_permlane16_swap_b32 v152, v20
	v_permlane16_swap_b32 v153, v21
	v_permlane16_swap_b32 v154, v22
	v_permlane16_swap_b32 v155, v23
	v_permlane16_swap_b32 v156, v24
	v_add_f32 v152, v152, v20
	v_add_f32 v153, v153, v21
	v_add_f32 v154, v154, v22
	v_add_f32 v155, v155, v23
	v_add_f32 v156, v156, v24
	v_bfi_b32 v152, s49, v1, v152
	v_bfi_b32 v153, s49, v1, v153
	v_bfi_b32 v154, s49, v1, v154
	v_bfi_b32 v155, s49, v1, v155
	s_mov_b32 exec_lo, 0xff
	s_mov_b32 exec_hi, 0x0
	buffer_store_dwordx4 v[152:155], v11, s[40:43], s68 offen sc1
	s_bitcmp1_b32 s3, 1
	s_cbranch_scc1 L14
	v_bfi_b32 v24, s49, v1, v39
	v_bfi_b32 v25, s49, v1, v156
	v_lshlrev_b32 v26, 20, v39
	v_or_b32 v26, v26, v1
	v_mov_b32 v27, v1
	s_mov_b32 exec_lo, 0x1
	s_mov_b32 exec_hi, 0x0
	buffer_store_dwordx4 v[24:27], v11, s[40:43], s67 offen offset:256 sc1
L14:
	s_mov_b64 exec, -1
	s_cmp_lt_u32 s2, 144
	s_cbranch_scc1 L_F_tail
	s_cmp_lt_u32 s2, 208
	s_cbranch_scc1 L_WO_tail
L_RED_tail:
	s_cmp_lt_u32 s62, 82
	s_cbranch_scc0 L15
	s_sub_u32 s62, s62, 64
	v_lshlrev_b32 v4, 4, v0
	s_lshl_b32 s50, s63, 10
	v_add_u32 v5, s50, v4
	s_cmp_lt_u32 s63, 8
	s_cbranch_scc0 L16
	s_lshl_b32 s51, s62, 13
	s_add_u32 s51, s51, s50
	s_add_u32 s51, s51, 0x80000
	s_mov_b32 s54, 0
Lp17:
	buffer_load_dwordx4 v[40:43], v4, s[40:43], s51 offen sc1
	s_waitcnt vmcnt(0)
	v_bitop3_b32 v6, v40, v41, v1 bitop3:0x7e
	v_bitop3_b32 v7, v42, v43, v1 bitop3:0x7e
	v_or_b32 v6, v6, v7
	v_and_b32 v6, s49, v6
	v_cmp_ne_u32 vcc, 0, v6
	s_cbranch_vccz Lok18
	s_add_u32 s54, s54, 1
	s_cmp_lt_u32 s54, 200000
	s_cbranch_scc1 Lp17
Lok18:
	v_add_f32_dpp v40, v40, v40 row_ror:8 row_mask:0xf bank_mask:0xf
	v_add_f32_dpp v41, v41, v41 row_ror:8 row_mask:0xf bank_mask:0xf
	v_add_f32_dpp v42, v42, v42 row_ror:8 row_mask:0xf bank_mask:0xf
	v_add_f32_dpp v43, v43, v43 row_ror:8 row_mask:0xf bank_mask:0xf
	v_permlane32_swap_b32 v40, v44
	v_permlane32_swap_b32 v41, v45
	v_permlane32_swap_b32 v42, v46
	v_permlane32_swap_b32 v43, v47
	v_add_f32 v40, v40, v44
	v_add_f32 v41, v41, v45
	v_add_f32 v42, v42, v46
	v_add_f32 v43, v43, v47
	v_permlane16_swap_b32 v40, v44
	v_permlane16_swap_b32 v41, v45
	v_permlane16_swap_b32 v42, v46
	v_permlane16_swap_b32 v43, v47
	v_add_f32 v40, v40, v44
	v_add_f32 v41, v41, v45
	v_add_f32 v42, v42, v46
	v_add_f32 v43, v43, v47
	s_lshl_b32 s52, s63, 7
	v_add_u32 v6, s52, v4
	s_mov_b32 exec_lo, 0xff
	s_mov_b32 exec_hi, 0x0
	ds_write_b128 v6, v[40:43] offset:1024
	s_mov_b64 exec, -1
L16:
	s_waitcnt lgkmcnt(0)
	s_barrier
	s_mul_i32 s51, s62, 18432
	s_lshl_b32 s50, s63, 11
	s_add_u32 s51, s51, s50
	s_add_u32 s51, s51, 0xb0000
	s_waitcnt lgkmcnt(0)
	s_barrier
	s_mov_b32 s54, 0
Lp19:
	buffer_load_dwordx4 v[40:43], v4, s[40:43], s51 offen sc1
	buffer_load_dwordx4 v[44:47], v4, s[40:43], s51 offen offset:1024 sc1
	s_waitcnt vmcnt(0)
	v_bitop3_b32 v6, v40, v41, v1 bitop3:0x7e
	v_bitop3_b32 v7, v42, v43, v1 bitop3:0x7e
	v_or_b32 v6, v6, v7
	v_bitop3_b32 v7, v44, v45, v1 bitop3:0x7e
	v_bitop3_b32 v8, v46, v47, v1 bitop3:0x7e
	v_or3_b32 v6, v6, v7, v8
	v_and_b32 v6, s49, v6
	v_cmp_ne_u32 vcc, 0, v6
	s_cbranch_vccz Lok20
	s_add_u32 s54, s54, 1
	s_cmp_lt_u32 s54, 200000
	s_cbranch_scc1 Lp19
Lok20:
	v_add_f32 v40, v40, v44
	v_add_f32 v41, v41, v45
	v_add_f32 v42, v42, v46
	v_add_f32 v43, v43, v47
	ds_write_b128 v5, v[40:43] offset:1024
	s_waitcnt lgkmcnt(0)
	s_barrier
L15:
	s_endpgm
L_WO_tail:
	s_nop 1
	v_lshrrev_b32 v5, 4, v0
	v_bfe_u32 v4, v0, 3, 1
	v_lshl_add_u32 v4, v5, 1, v4
	v_lshlrev_b32 v5, 5, v4
	v_and_b32 v8, 7, v0
	v_bfe_u32 v7, v0, 4, 1
	v_mul_u32_u24 v10, 8192, v7
	v_lshl_add_u32 v10, v8, 4, v10
	s_mul_i32 s67, s63, 16384
	s_lshl_b32 s52, s62, 7
	s_add_u32 s67, s67, s52
	s_add_u32 s67, s67, 0x80000
	s_waitcnt vmcnt(0)
	s_waitcnt lgkmcnt(0)
	s_barrier
	ds_read_b128 v[152:155], v5 offset:13824
	ds_read_b128 v[156:159], v5 offset:13840
	s_waitcnt lgkmcnt(0)
	v_and_b32 v20, v152, v12
	v_and_b32 v21, v152, v13
	v_and_b32 v22, v152, v14
	v_and_b32 v23, v152, v15
	v_and_b32 v24, v153, v12
	v_and_b32 v25, v153, v13
	v_and_b32 v26, v153, v14
	v_and_b32 v27, v153, v15
	v_and_b32 v16, v154, v12
	v_and_b32 v17, v154, v13
	v_and_b32 v18, v154, v14
	v_and_b32 v19, v154, v15
	v_mfma_f32_16x16x32_bf16 v[28:31], v[120:123], v[20:23], 0
	v_and_b32 v20, v155, v12
	v_and_b32 v21, v155, v13
	v_and_b32 v22, v155, v14
	v_and_b32 v23, v155, v15
	v_mfma_f32_16x16x32_bf16 v[32:35], v[124:127], v[24:27], 0
	v_and_b32 v24, v156, v12
	v_and_b32 v25, v156, v13
	v_and_b32 v26, v156, v14
	v_and_b32 v27, v156, v15
	v_mfma_f32_16x16x32_bf16 v[28:31], v[128:131], v[16:19], v[28:31]
	v_and_b32 v16, v157, v12
	v_and_b32 v17, v157, v13
	v_and_b32 v18, v157, v14
	v_and_b32 v19, v157, v15
	v_mfma_f32_16x16x32_bf16 v[32:35], v[132:135], v[20:23], v[32:35]
	v_and_b32 v20, v158, v12
	v_and_b32 v21, v158, v13
	v_and_b32 v22, v158, v14
	v_and_b32 v23, v158, v15
	v_mfma_f32_16x16x32_bf16 v[28:31], v[136:139], v[24:27], v[28:31]
	v_and_b32 v24, v159, v12
	v_and_b32 v25, v159, v13
	v_and_b32 v26, v159, v14
	v_and_b32 v27, v159, v15
	v_mfma_f32_16x16x32_bf16 v[32:35], v[140:143], v[16:19], v[32:35]
	v_mfma_f32_16x16x32_bf16 v[28:31], v[144:147], v[20:23], v[28:31]
	v_mfma_f32_16x16x32_bf16 v[32:35], v[148:151], v[24:27], v[32:35]
	s_nop 7
	v_add_f32 v28, v28, v32
	v_add_f32 v29, v29, v33
	v_add_f32 v30, v30, v34
	v_add_f32 v31, v31, v35
	v_permlane32_swap_b32 v28, v20
	v_permlane32_swap_b32 v29, v21
	v_permlane32_swap_b32 v30, v22
	v_permlane32_swap_b32 v31, v23
	v_add_f32_dpp v28, v20, v28 row_ror:8 row_mask:0xf bank_mask:0xf
	v_add_f32_dpp v29, v21, v29 row_ror:8 row_mask:0xf bank_mask:0xf
	v_add_f32_dpp v30, v22, v30 row_ror:8 row_mask:0xf bank_mask:0xf
	v_add_f32_dpp v31, v23, v31 row_ror:8 row_mask:0xf bank_mask:0xf
	v_bfi_b32 v28, s49, v1, v28
	v_bfi_b32 v29, s49, v1, v29
	v_bfi_b32 v30, s49, v1, v30
	v_bfi_b32 v31, s49, v1, v31
	s_mov_b32 exec_lo, 0xff00ff
	s_mov_b32 exec_hi, 0x0
	buffer_store_dwordx4 v[28:31], v10, s[40:43], s67 offen sc1
	s_endpgm
L_F_tail:
	s_nop 1
	s_barrier
	buffer_load_dwordx4 v[44:47], v36, s[32:35], s58 offen nt
	s_add_u32 s58, s58, s59
	buffer_load_dwordx4 v[60:63], v36, s[36:39], s60 offen nt
	s_add_u32 s60, s60, s59
	s_waitcnt vmcnt(3)
	buffer_load_dwordx4 v[48:51], v36, s[32:35], s58 offen nt
	s_add_u32 s58, s58, s59
	s_waitcnt vmcnt(3)
	buffer_load_dwordx4 v[64:67], v36, s[36:39], s60 offen nt
	s_add_u32 s60, s60, s59
	s_waitcnt vmcnt(3)
	buffer_load_dwordx4 v[52:55], v36, s[32:35], s58 offen nt
	s_waitcnt vmcnt(3)
	buffer_load_dwordx4 v[68:71], v36, s[36:39], s60 offen nt
	s_waitcnt vmcnt(3)
	global_load_dwordx4 v[92:95], v38, s[64:65] nt
	s_add_u32 s64, s64, 9216
	s_addc_u32 s65, s65, 0
	s_waitcnt vmcnt(3)
	global_load_dwordx4 v[96:99], v38, s[64:65] nt
	s_add_u32 s64, s64, 9216
	s_addc_u32 s65, s65, 0
	s_waitcnt vmcnt(3)
	global_load_dwordx4 v[100:103], v38, s[64:65] nt
	s_add_u32 s64, s64, 9216
	s_addc_u32 s65, s65, 0
	s_waitcnt vmcnt(3)
	global_load_dwordx4 v[104:107], v38, s[64:65] nt
	v_lshrrev_b32 v5, 4, v0
	v_bfe_u32 v4, v0, 3, 1
	v_lshl_add_u32 v4, v5, 1, v4
	s_and_b32 s50, s62, 1
	s_mul_i32 s50, s50, 9
	s_add_u32 s50, s50, s63
	s_lshl_b32 s68, s50, 7
	s_add_u32 s68, s68, 0xa8000
	v_lshlrev_b32 v5, 4, v4
	v_and_b32 v8, 7, v0
	v_bfe_u32 v7, v0, 4, 1
	v_mul_u32_u24 v10, 18432, v7
	v_lshl_add_u32 v10, v8, 4, v10
	s_mul_i32 s67, s63, 36864
	s_lshl_b32 s52, s62, 7
	s_add_u32 s67, s67, s52
	s_add_u32 s67, s67, 0xb0000
	v_lshlrev_b32 v6, 4, v4
	v_lshlrev_b32 v9, 7, v7
	v_lshl_add_u32 v9, v8, 4, v9
	s_lshl_b32 s52, s63, 9
	v_add_u32 v9, s52, v9
	s_lshl_b32 s56, s63, 3
	s_mov_b32 s96, 0x03020302
	v_and_b32 v20, 0x3f803f80, v12
	v_and_b32 v21, 0x3f803f80, v13
	v_and_b32 v22, 0x3f803f80, v14
	v_and_b32 v23, 0x3f803f80, v15
	s_nop 1
	v_mfma_f32_16x16x32_bf16 v[28:31], v[40:43], v[20:23], 0
	v_mfma_f32_16x16x32_bf16 v[32:35], v[56:59], v[20:23], 0
	v_mfma_f32_16x16x32_bf16 v[28:31], v[44:47], v[20:23], v[28:31]
	v_mfma_f32_16x16x32_bf16 v[32:35], v[60:63], v[20:23], v[32:35]
	v_mfma_f32_16x16x32_bf16 v[28:31], v[48:51], v[20:23], v[28:31]
	v_mfma_f32_16x16x32_bf16 v[32:35], v[64:67], v[20:23], v[32:35]
	v_mfma_f32_16x16x32_bf16 v[28:31], v[52:55], v[20:23], v[28:31]
	v_mfma_f32_16x16x32_bf16 v[32:35], v[68:71], v[20:23], v[32:35]
	s_nop 6
	v_permlane32_swap_b32 v28, v24
	v_permlane32_swap_b32 v29, v25
	v_permlane32_swap_b32 v30, v26
	v_permlane32_swap_b32 v31, v27
	v_add_f32_dpp v28, v24, v28 row_ror:8 row_mask:0xf bank_mask:0xf
	v_add_f32_dpp v29, v25, v29 row_ror:8 row_mask:0xf bank_mask:0xf
	v_add_f32_dpp v30, v26, v30 row_ror:8 row_mask:0xf bank_mask:0xf
	v_add_f32_dpp v31, v27, v31 row_ror:8 row_mask:0xf bank_mask:0xf
	v_permlane32_swap_b32 v32, v16
	v_permlane32_swap_b32 v33, v17
	v_permlane32_swap_b32 v34, v18
	v_permlane32_swap_b32 v35, v19
	v_add_f32_dpp v32, v16, v32 row_ror:8 row_mask:0xf bank_mask:0xf
	v_add_f32_dpp v33, v17, v33 row_ror:8 row_mask:0xf bank_mask:0xf
	v_add_f32_dpp v34, v18, v34 row_ror:8 row_mask:0xf bank_mask:0xf
	v_add_f32_dpp v35, v19, v35 row_ror:8 row_mask:0xf bank_mask:0xf
	s_mov_b32 exec_lo, 0xff00ff
	s_mov_b32 exec_hi, 0x0
	ds_write_b128 v9, v[28:31] offset:19456
	ds_write_b128 v9, v[32:35] offset:19712
	s_mov_b64 exec, -1
	s_waitcnt lgkmcnt(0)
	s_barrier
	s_waitcnt vmcnt(0)
	s_mov_b32 s54, 0
Lp21:
	buffer_load_dwordx4 v[152:155], v5, s[40:43], s68 offen sc1
	s_waitcnt vmcnt(0)
	v_bitop3_b32 v4, v152, v153, v1 bitop3:0x7e
	v_bitop3_b32 v156, v154, v155, v1 bitop3:0x7e
	v_or_b32 v4, v4, v156
	v_and_b32 v4, s49, v4
	v_cmp_ne_u32 vcc, 0, v4
	s_cbranch_vccz Lok22
	s_add_u32 s54, s54, 1
	s_cmp_lt_u32 s54, 200000
	s_cbranch_scc1 Lp21
Lok22:
	v_perm_b32 v152, v152, v152, s96
	v_perm_b32 v153, v153, v153, s96
	v_perm_b32 v154, v154, v154, s96
	v_perm_b32 v155, v155, v155, s96
	v_and_b32 v20, v152, v12
	v_and_b32 v21, v152, v13
	v_and_b32 v22, v152, v14
	v_and_b32 v23, v152, v15
	v_and_b32 v24, v153, v12
	v_and_b32 v25, v153, v13
	v_and_b32 v26, v153, v14
	v_and_b32 v27, v153, v15
	v_and_b32 v16, v154, v12
	v_and_b32 v17, v154, v13
	v_and_b32 v18, v154, v14
	v_and_b32 v19, v154, v15
	v_mfma_f32_16x16x32_bf16 v[28:31], v[40:43], v[20:23], 0
	v_mfma_f32_16x16x32_bf16 v[32:35], v[56:59], v[20:23], 0
	v_and_b32 v76, v155, v12
	v_and_b32 v77, v155, v13
	v_and_b32 v78, v155, v14
	v_and_b32 v79, v155, v15
	v_mfma_f32_16x16x32_bf16 v[28:31], v[44:47], v[24:27], v[28:31]
	v_mfma_f32_16x16x32_bf16 v[32:35], v[60:63], v[24:27], v[32:35]
	v_mfma_f32_16x16x32_bf16 v[28:31], v[48:51], v[16:19], v[28:31]
	v_mfma_f32_16x16x32_bf16 v[32:35], v[64:67], v[16:19], v[32:35]
	v_mfma_f32_16x16x32_bf16 v[28:31], v[52:55], v[76:79], v[28:31]
	v_mfma_f32_16x16x32_bf16 v[32:35], v[68:71], v[76:79], v[32:35]
	s_nop 6
	v_permlane32_swap_b32 v28, v80
	v_permlane32_swap_b32 v29, v81
	v_permlane32_swap_b32 v30, v82
	v_permlane32_swap_b32 v31, v83
	v_add_f32_dpp v28, v80, v28 row_ror:8 row_mask:0xf bank_mask:0xf
	v_add_f32_dpp v29, v81, v29 row_ror:8 row_mask:0xf bank_mask:0xf
	v_add_f32_dpp v30, v82, v30 row_ror:8 row_mask:0xf bank_mask:0xf
	v_add_f32_dpp v31, v83, v31 row_ror:8 row_mask:0xf bank_mask:0xf
	v_permlane32_swap_b32 v32, v84
	v_permlane32_swap_b32 v33, v85
	v_permlane32_swap_b32 v34, v86
	v_permlane32_swap_b32 v35, v87
	v_add_f32_dpp v32, v84, v32 row_ror:8 row_mask:0xf bank_mask:0xf
	v_add_f32_dpp v33, v85, v33 row_ror:8 row_mask:0xf bank_mask:0xf
	v_add_f32_dpp v34, v86, v34 row_ror:8 row_mask:0xf bank_mask:0xf
	v_add_f32_dpp v35, v87, v35 row_ror:8 row_mask:0xf bank_mask:0xf
	s_mov_b32 exec_lo, 0xff00ff
	s_mov_b32 exec_hi, 0x0
	ds_write_b128 v9, v[28:31] offset:14336
	ds_write_b128 v9, v[32:35] offset:14592
	s_mov_b64 exec, -1
	s_waitcnt lgkmcnt(0)
	s_barrier
	s_waitcnt lgkmcnt(0)
	s_barrier
	ds_read_b128 v[152:155], v6 offset:14080
	s_waitcnt lgkmcnt(0)
	v_and_b32 v20, v152, v12
	v_and_b32 v21, v152, v13
	v_and_b32 v22, v152, v14
	v_and_b32 v23, v152, v15
	v_and_b32 v24, v153, v12
	v_and_b32 v25, v153, v13
	v_and_b32 v26, v153, v14
	v_and_b32 v27, v153, v15
	v_and_b32 v16, v154, v12
	v_and_b32 v17, v154, v13
	v_and_b32 v18, v154, v14
	v_and_b32 v19, v154, v15
	v_mfma_f32_16x16x32_bf16 v[28:31], v[92:95], v[20:23], 0
	v_and_b32 v20, v155, v12
	v_and_b32 v21, v155, v13
	v_and_b32 v22, v155, v14
	v_and_b32 v23, v155, v15
	v_mfma_f32_16x16x32_bf16 v[32:35], v[96:99], v[24:27], 0
	v_mfma_f32_16x16x32_bf16 v[28:31], v[100:103], v[16:19], v[28:31]
	v_mfma_f32_16x16x32_bf16 v[32:35], v[104:107], v[20:23], v[32:35]
	s_nop 7
	v_add_f32 v28, v28, v32
	v_add_f32 v29, v29, v33
	v_add_f32 v30, v30, v34
	v_add_f32 v31, v31, v35
	v_permlane32_swap_b32 v28, v20
	v_permlane32_swap_b32 v29, v21
	v_permlane32_swap_b32 v30, v22
	v_permlane32_swap_b32 v31, v23
	v_add_f32_dpp v28, v20, v28 row_ror:8 row_mask:0xf bank_mask:0xf
	v_add_f32_dpp v29, v21, v29 row_ror:8 row_mask:0xf bank_mask:0xf
	v_add_f32_dpp v30, v22, v30 row_ror:8 row_mask:0xf bank_mask:0xf
	v_add_f32_dpp v31, v23, v31 row_ror:8 row_mask:0xf bank_mask:0xf
	v_bfi_b32 v28, s49, v1, v28
	v_bfi_b32 v29, s49, v1, v29
	v_bfi_b32 v30, s49, v1, v30
	v_bfi_b32 v31, s49, v1, v31
	s_mov_b32 exec_lo, 0xff00ff
	s_mov_b32 exec_hi, 0x0
	buffer_store_dwordx4 v[28:31], v10, s[40:43], s67 offen sc1
	s_endpgm
L_end:
	s_endpgm
L_aux:
	s_mov_b32 s63, 8
	v_lshlrev_b32 v4, 4, v0
	v_mov_b32 v20, 0
	v_mov_b32 v21, 0
	v_mov_b32 v22, 0
	v_mov_b32 v23, 0
	s_mov_b32 exec_lo, 0xffffffff
	s_mov_b32 exec_hi, 0x0
	ds_write_b128 v4, v[20:23] offset:18944
	ds_write_b128 v4, v[20:23] offset:24064
	s_mov_b64 exec, -1
	s_cmp_lt_u32 s2, 144
	s_cbranch_scc0 L23
	s_lshr_b32 s50, s5, 1
	s_mul_i32 s51, s4, 9
	s_add_u32 s50, s50, s51
	s_lshl_b32 s50, s50, 1
	s_and_b32 s51, s5, 1
	s_add_u32 s62, s50, s51
	s_branch L24
L23:
	s_sub_u32 s62, s2, 144
L24:
	s_waitcnt lgkmcnt(0)
	s_mov_b32 s40, s30
	s_and_b32 s41, s31, 0xffff
	s_mov_b32 s42, 0x300000
	s_mov_b32 s43, 0x20000
	s_load_dword s66, s[30:31], 0x0
	s_waitcnt vmcnt(0)
	v_and_b32 v4, 1, v0
	v_lshlrev_b32 v4, 4, v4
	v_mov_b32 v5, 0xffff
	v_lshlrev_b32 v4, v4, v5
	v_bfe_u32 v5, v0, 1, 2
	v_cmp_eq_u32 vcc, 0, v5
	s_nop 1
	v_cndmask_b32 v12, 0, v4, vcc
	v_cmp_eq_u32 vcc, 1, v5
	s_nop 1
	v_cndmask_b32 v13, 0, v4, vcc
	v_cmp_eq_u32 vcc, 2, v5
	s_nop 1
	v_cndmask_b32 v14, 0, v4, vcc
	v_cmp_eq_u32 vcc, 3, v5
	s_nop 1
	v_cndmask_b32 v15, 0, v4, vcc
	s_mov_b32 s58, 0
	s_mov_b32 s59, 0
	s_mov_b32 s60, 0
	s_mov_b64 s[64:65], s[24:25]
	v_mov_b32 v36, 0
	v_mov_b32 v38, 0
	s_cmp_lt_u32 s2, 144
	s_cbranch_scc1 L_aux_F
	s_cmp_lt_u32 s2, 208
	s_cbranch_scc1 L_aux_WO
	s_waitcnt lgkmcnt(0)
	s_add_u32 s48, s66, 1
	s_and_b32 s48, s48, 0xfff
	s_movk_i32 s49, 0xfff
	v_mov_b32 v1, s48
	s_branch L_RED_tail
L_aux_WO:
	v_lshrrev_b32 v6, 4, v0
	v_bfe_u32 v4, v0, 3, 1
	v_lshl_add_u32 v4, v6, 1, v4
	v_mul_u32_u24 v38, 1152, v4
	v_and_b32 v6, 7, v0
	v_lshl_add_u32 v38, v6, 4, v38
	s_mul_i32 s50, s62, 73728
	s_lshl_b32 s51, s63, 7
	s_add_u32 s50, s50, s51
	s_add_u32 s64, s16, s50
	s_addc_u32 s65, s17, 0
	global_load_dwordx4 v[120:123], v38, s[64:65] nt
	s_add_u32 s64, s64, 9216
	s_addc_u32 s65, s65, 0
	global_load_dwordx4 v[124:127], v38, s[64:65] nt
	s_add_u32 s64, s64, 9216
	s_addc_u32 s65, s65, 0
	global_load_dwordx4 v[128:131], v38, s[64:65] nt
	s_add_u32 s64, s64, 9216
	s_addc_u32 s65, s65, 0
	s_waitcnt vmcnt(2)
	global_load_dwordx4 v[132:135], v38, s[64:65] nt
	s_add_u32 s64, s64, 9216
	s_addc_u32 s65, s65, 0
	s_waitcnt vmcnt(2)
	global_load_dwordx4 v[136:139], v38, s[64:65] nt
	s_add_u32 s64, s64, 9216
	s_addc_u32 s65, s65, 0
	s_waitcnt vmcnt(2)
	global_load_dwordx4 v[140:143], v38, s[64:65] nt
	s_add_u32 s64, s64, 9216
	s_addc_u32 s65, s65, 0
	s_waitcnt vmcnt(2)
	global_load_dwordx4 v[144:147], v38, s[64:65] nt
	s_add_u32 s64, s64, 9216
	s_addc_u32 s65, s65, 0
	s_waitcnt vmcnt(2)
	global_load_dwordx4 v[148:151], v38, s[64:65] nt
	s_waitcnt lgkmcnt(0)
	s_add_u32 s48, s66, 1
	s_and_b32 s48, s48, 0xfff
	s_movk_i32 s49, 0xfff
	v_mov_b32 v1, s48
	s_branch L_WO_tail
L_aux_F:
	v_lshrrev_b32 v6, 4, v0
	v_bfe_u32 v4, v0, 3, 1
	v_lshl_add_u32 v4, v6, 1, v4
	s_movk_i32 s51, 9216
	v_mul_lo_u32 v36, v4, s51
	v_and_b32 v6, 7, v0
	v_lshl_add_u32 v36, v6, 4, v36
	s_and_b32 s50, s62, 1
	s_mul_i32 s50, s50, 288
	s_lshl_b32 s52, s63, 5
	s_add_u32 s50, s50, s52
	s_mul_i32 s50, s50, 9216
	s_lshr_b32 s52, s62, 1
	s_lshl_b32 s52, s52, 7
	s_add_u32 s50, s50, s52
	s_mov_b32 s58, s50
	s_mov_b32 s60, s50
	s_mov_b32 s59, 73728
	v_mul_u32_u24 v38, 1152, v4
	v_lshl_add_u32 v38, v6, 4, v38
	s_mul_i32 s50, s62, 36864
	s_lshl_b32 s51, s63, 7
	s_add_u32 s50, s50, s51
	s_add_u32 s64, s24, s50
	s_addc_u32 s65, s25, 0
	s_waitcnt lgkmcnt(0)
	s_add_u32 s48, s66, 1
	s_and_b32 s48, s48, 0xfff
	s_movk_i32 s49, 0xfff
	v_mov_b32 v1, s48
	v_mov_b32 v4, 0
	s_mov_b32 s32, s20
	s_and_b32 s33, s21, 0xffff
	s_mov_b32 s34, 0x510000
	s_mov_b32 s35, 0x20000
	s_mov_b32 s36, s22
	s_and_b32 s37, s23, 0xffff
	s_mov_b32 s38, 0x510000
	s_mov_b32 s39, 0x20000
	s_cmp_lt_u32 s2, 144
	s_cselect_b32 s34, s34, 0
	s_cselect_b32 s38, s38, 0
Lw25:
	ds_read_b32 v5, v4 offset:804
	s_waitcnt lgkmcnt(0)
	v_readfirstlane_b32 s54, v5
	s_cmp_lg_u32 s54, 8
	s_cbranch_scc1 Lw25
	buffer_load_dwordx4 v[40:43], v36, s[32:35], s58 offen nt
	s_add_u32 s58, s58, s59
	buffer_load_dwordx4 v[56:59], v36, s[36:39], s60 offen nt
	s_add_u32 s60, s60, s59
	s_branch L_F_tail
L_ch_roles:
	s_waitcnt vmcnt(0)
	s_cmp_lt_u32 s2, 144
	s_cbranch_scc1 L_ch_F
	s_cmp_lt_u32 s2, 208
	s_cbranch_scc1 L_ch_WO
	s_cmp_lt_u32 s62, 82
	s_cbranch_scc1 L_ch_R18
	s_endpgm
L_ch_R18:
	s_sub_u32 s62, s62, 64
	v_and_b32 v4, 7, v0
	v_lshlrev_b32 v5, 1, v4
	s_lshl_b32 s69, s62, 6
	buffer_load_ushort v136, v5, s[44:47], s69 offen offset:0
	buffer_load_ushort v137, v5, s[44:47], s69 offen offset:16
	buffer_load_ushort v138, v5, s[44:47], s69 offen offset:32
	buffer_load_ushort v139, v5, s[44:47], s69 offen offset:48
	v_lshlrev_b32 v6, 4, v0
	s_lshl_b32 s67, s62, 7
	s_add_u32 s67, s67, 0xa8000
	v_lshlrev_b32 v7, 4, v4
	s_waitcnt vmcnt(0)
	v_lshlrev_b32 v136, 16, v136
	v_lshlrev_b32 v137, 16, v137
	v_lshlrev_b32 v138, 16, v138
	v_lshlrev_b32 v139, 16, v139
	s_mov_b32 s44, s26
	s_and_b32 s45, s27, 0xffff
	s_mov_b32 s46, 0x480
	s_mov_b32 s47, 0x20000
	s_waitcnt lgkmcnt(0)
	s_barrier
	ds_read_b128 v[64:67], v6 offset:1024
	s_waitcnt lgkmcnt(0)
	v_add_f32_dpp v64, v64, v64 row_ror:8 row_mask:0xf bank_mask:0xf
	v_add_f32_dpp v65, v65, v65 row_ror:8 row_mask:0xf bank_mask:0xf
	v_add_f32_dpp v66, v66, v66 row_ror:8 row_mask:0xf bank_mask:0xf
	v_add_f32_dpp v67, v67, v67 row_ror:8 row_mask:0xf bank_mask:0xf
	v_permlane32_swap_b32 v64, v20
	v_permlane32_swap_b32 v65, v21
	v_permlane32_swap_b32 v66, v22
	v_permlane32_swap_b32 v67, v23
	v_add_f32 v64, v64, v20
	v_add_f32 v65, v65, v21
	v_add_f32 v66, v66, v22
	v_add_f32 v67, v67, v23
	v_permlane16_swap_b32 v64, v20
	v_permlane16_swap_b32 v65, v21
	v_permlane16_swap_b32 v66, v22
	v_permlane16_swap_b32 v67, v23
	v_add_f32 v64, v64, v20
	v_add_f32 v65, v65, v21
	v_add_f32 v66, v66, v22
	v_add_f32 v67, v67, v23
	v_cvt_pk_bf16_f32 v64, v64, v64
	v_cvt_pk_bf16_f32 v65, v65, v65
	v_cvt_pk_bf16_f32 v66, v66, v66
	v_cvt_pk_bf16_f32 v67, v67, v67
	v_and_b32 v64, 0xffff0000, v64
	v_and_b32 v65, 0xffff0000, v65
	v_and_b32 v66, 0xffff0000, v66
	v_and_b32 v67, 0xffff0000, v67
	v_add_f32 v140, v64, v136
	v_add_f32 v141, v65, v137
	v_add_f32 v142, v66, v138
	v_add_f32 v143, v67, v139
	v_cvt_pk_bf16_f32 v140, v140, v140
	v_cvt_pk_bf16_f32 v141, v141, v141
	v_cvt_pk_bf16_f32 v142, v142, v142
	v_cvt_pk_bf16_f32 v143, v143, v143
	v_and_b32 v140, 0xffff0000, v140
	v_and_b32 v141, 0xffff0000, v141
	v_and_b32 v142, 0xffff0000, v142
	v_and_b32 v143, 0xffff0000, v143
	v_or_b32 v136, s48, v140
	v_or_b32 v137, s48, v141
	v_or_b32 v138, s48, v142
	v_or_b32 v139, s48, v143
	s_mov_b32 exec_lo, 0xff
	s_mov_b32 exec_hi, 0x0
	buffer_store_dwordx4 v[136:139], v7, s[40:43], s67 offen sc1
	s_mov_b64 exec, -1
	s_waitcnt lgkmcnt(0)
	s_barrier
	s_waitcnt lgkmcnt(0)
	s_barrier
	ds_read_b128 v[64:67], v6 offset:1024
	ds_read_b128 v[68:71], v6 offset:2048
	ds_read_b128 v[72:75], v6 offset:3072
	ds_read_b128 v[76:79], v6 offset:4096
	ds_read_b128 v[80:83], v6 offset:5120
	ds_read_b128 v[84:87], v6 offset:6144
	ds_read_b128 v[88:91], v6 offset:7168
	ds_read_b128 v[92:95], v6 offset:8192
	ds_read_b128 v[96:99], v6 offset:9216
	s_waitcnt lgkmcnt(0)
	v_add_f32 v64, v64, v68
	v_add_f32 v65, v65, v69
	v_add_f32 v66, v66, v70
	v_add_f32 v67, v67, v71
	v_add_f32 v72, v72, v76
	v_add_f32 v73, v73, v77
	v_add_f32 v74, v74, v78
	v_add_f32 v75, v75, v79
	v_add_f32 v80, v80, v84
	v_add_f32 v81, v81, v85
	v_add_f32 v82, v82, v86
	v_add_f32 v83, v83, v87
	v_add_f32 v88, v88, v92
	v_add_f32 v89, v89, v93
	v_add_f32 v90, v90, v94
	v_add_f32 v91, v91, v95
	v_add_f32 v64, v64, v72
	v_add_f32 v65, v65, v73
	v_add_f32 v66, v66, v74
	v_add_f32 v67, v67, v75
	v_add_f32 v80, v80, v88
	v_add_f32 v81, v81, v89
	v_add_f32 v82, v82, v90
	v_add_f32 v83, v83, v91
	v_add_f32 v64, v64, v80
	v_add_f32 v65, v65, v81
	v_add_f32 v66, v66, v82
	v_add_f32 v67, v67, v83
	v_add_f32 v64, v64, v96
	v_add_f32 v65, v65, v97
	v_add_f32 v66, v66, v98
	v_add_f32 v67, v67, v99
	v_add_f32_dpp v64, v64, v64 row_ror:8 row_mask:0xf bank_mask:0xf
	v_add_f32_dpp v65, v65, v65 row_ror:8 row_mask:0xf bank_mask:0xf
	v_add_f32_dpp v66, v66, v66 row_ror:8 row_mask:0xf bank_mask:0xf
	v_add_f32_dpp v67, v67, v67 row_ror:8 row_mask:0xf bank_mask:0xf
	v_permlane32_swap_b32 v64, v20
	v_permlane32_swap_b32 v65, v21
	v_permlane32_swap_b32 v66, v22
	v_permlane32_swap_b32 v67, v23
	v_add_f32 v64, v64, v20
	v_add_f32 v65, v65, v21
	v_add_f32 v66, v66, v22
	v_add_f32 v67, v67, v23
	v_permlane16_swap_b32 v64, v20
	v_permlane16_swap_b32 v65, v21
	v_permlane16_swap_b32 v66, v22
	v_permlane16_swap_b32 v67, v23
	v_add_f32 v64, v64, v20
	v_add_f32 v65, v65, v21
	v_add_f32 v66, v66, v22
	v_add_f32 v67, v67, v23
	v_cvt_pk_bf16_f32 v64, v64, v64
	v_and_b32 v64, 0xffff0000, v64
	v_cvt_pk_bf16_f32 v65, v65, v65
	v_and_b32 v65, 0xffff0000, v65
	v_cvt_pk_bf16_f32 v66, v66, v66
	v_and_b32 v66, 0xffff0000, v66
	v_cvt_pk_bf16_f32 v67, v67, v67
	v_and_b32 v67, 0xffff0000, v67
	v_add_f32 v64, v64, v140
	v_add_f32 v65, v65, v141
	v_add_f32 v66, v66, v142
	v_add_f32 v67, v67, v143
	v_cvt_pk_bf16_f32 v64, v64, v64
	v_cvt_pk_bf16_f32 v65, v65, v65
	v_cvt_pk_bf16_f32 v66, v66, v66
	v_cvt_pk_bf16_f32 v67, v67, v67
	s_mov_b32 exec_lo, 0xff
	s_mov_b32 exec_hi, 0x0
	buffer_store_short v64, v5, s[44:47], s69 offen offset:0
	buffer_store_short v65, v5, s[44:47], s69 offen offset:16
	buffer_store_short v66, v5, s[44:47], s69 offen offset:32
	buffer_store_short v67, v5, s[44:47], s69 offen offset:48
	s_cmp_eq_u32 s62, 0
	s_cbranch_scc0 L27
	s_mov_b32 exec_lo, 0x1
	s_mov_b32 exec_hi, 0x0
	v_mov_b32 v4, s48
	v_mov_b32 v8, 0
	buffer_store_dword v4, v8, s[40:43], 0 offen offset:0
L27:
	s_endpgm
L_ch_WO:
	v_lshrrev_b32 v5, 4, v0
	v_mul_u32_u24 v5, 384, v5
	v_and_b32 v4, 15, v0
	v_lshl_add_u32 v4, v4, 4, v5
	s_mul_i32 s50, s62, 6144
	s_add_u32 s52, s50, 0x20000
	s_add_u32 s53, s52, 3072
	s_add_u32 s50, s50, 0x20000
	s_add_u32 s51, s50, 3072
	v_and_b32 v10, 7, v0
	v_lshlrev_b32 v10, 5, v10
	v_bfe_u32 v11, v0, 3, 1
	v_lshl_add_u32 v10, v11, 4, v10
	v_mov_b32 v11, 0
Lw28:
	ds_read_b32 v12, v11 offset:804
	s_waitcnt lgkmcnt(0)
	v_readfirstlane_b32 s54, v12
	s_cmp_lg_u32 s54, 8
	s_cbranch_scc1 Lw28
	s_mov_b32 s54, 0
Lp29:
	buffer_load_dwordx4 v[64:67], v4, s[40:43], s50 offen offset:0 sc1
	buffer_load_dwordx4 v[68:71], v4, s[40:43], s50 offen offset:1536 sc1
	buffer_load_dwordx4 v[72:75], v4, s[40:43], s51 offen offset:0 sc1
	buffer_load_dwordx4 v[76:79], v4, s[40:43], s51 offen offset:1536 sc1
	buffer_load_dwordx4 v[80:83], v5, s[40:43], s50 offen offset:256 sc1
	buffer_load_dwordx4 v[84:87], v5, s[40:43], s50 offen offset:1792 sc1
	buffer_load_dwordx4 v[88:91], v5, s[40:43], s51 offen offset:256 sc1
	buffer_load_dwordx4 v[92:95], v5, s[40:43], s51 offen offset:1792 sc1
	s_waitcnt vmcnt(0)
	v_bitop3_b32 v6, v64, v65, v1 bitop3:0x7e
	v_bitop3_b32 v7, v66, v67, v1 bitop3:0x7e
	v_or_b32 v6, v6, v7
	v_bitop3_b32 v7, v68, v69, v1 bitop3:0x7e
	v_bitop3_b32 v8, v70, v71, v1 bitop3:0x7e
	v_or3_b32 v6, v6, v7, v8
	v_bitop3_b32 v7, v72, v73, v1 bitop3:0x7e
	v_bitop3_b32 v8, v74, v75, v1 bitop3:0x7e
	v_or3_b32 v6, v6, v7, v8
	v_bitop3_b32 v7, v76, v77, v1 bitop3:0x7e
	v_bitop3_b32 v8, v78, v79, v1 bitop3:0x7e
	v_or3_b32 v6, v6, v7, v8
	v_bitop3_b32 v7, v80, v81, v1 bitop3:0x7e
	v_bitop3_b32 v8, v82, v83, v1 bitop3:0x7e
	v_or3_b32 v6, v6, v7, v8
	v_bitop3_b32 v7, v84, v85, v1 bitop3:0x7e
	v_bitop3_b32 v8, v86, v87, v1 bitop3:0x7e
	v_or3_b32 v6, v6, v7, v8
	v_bitop3_b32 v7, v88, v89, v1 bitop3:0x7e
	v_bitop3_b32 v8, v90, v91, v1 bitop3:0x7e
	v_or3_b32 v6, v6, v7, v8
	v_bitop3_b32 v7, v92, v93, v1 bitop3:0x7e
	v_bitop3_b32 v8, v94, v95, v1 bitop3:0x7e
	v_or3_b32 v6, v6, v7, v8
	v_and_b32 v6, s49, v6
	v_cmp_ne_u32 vcc, 0, v6
	s_cbranch_vccz Lok30
	s_add_u32 s54, s54, 1
	s_cmp_eq_u32 s54, 96
	s_cselect_b32 s50, s52, s50
	s_cselect_b32 s51, s53, s51
	s_cmp_lt_u32 s54, 200000
	s_cbranch_scc1 Lp29
Lok30:
	v_lshrrev_b32 v82, 20, v82
	v_lshrrev_b32 v86, 20, v86
	v_lshrrev_b32 v90, 20, v90
	v_lshrrev_b32 v94, 20, v94
	v_bfi_b32 v80, s49, v82, v80
	v_bfi_b32 v84, s49, v86, v84
	v_bfi_b32 v88, s49, v90, v88
	v_bfi_b32 v92, s49, v94, v92
	v_max3_f32 v6, v80, v84, v88
	v_max_f32 v6, v6, v92
	v_mov_b32 v7, v6
	s_nop 1
	v_permlane16_swap_b32 v7, v6
	v_max_f32 v6, v6, v7
	v_mov_b32 v7, v6
	s_nop 1
	v_permlane32_swap_b32 v7, v6
	v_max_f32 v6, v6, v7
	v_sub_f32 v80, v80, v6
	v_sub_f32 v84, v84, v6
	v_sub_f32 v88, v88, v6
	v_sub_f32 v92, v92, v6
	v_exp_f32 v80, v80
	v_exp_f32 v84, v84
	v_exp_f32 v88, v88
	v_exp_f32 v92, v92
	v_mul_f32 v8, v80, v81
	v_mul_f32 v32, v64, v80
	v_mul_f32 v33, v65, v80
	v_mul_f32 v34, v66, v80
	v_mul_f32 v35, v67, v80
	v_fmac_f32 v8, v84, v85
	v_fmac_f32 v32, v68, v84
	v_fmac_f32 v33, v69, v84
	v_fmac_f32 v34, v70, v84
	v_fmac_f32 v35, v71, v84
	v_fmac_f32 v8, v88, v89
	v_fmac_f32 v32, v72, v88
	v_fmac_f32 v33, v73, v88
	v_fmac_f32 v34, v74, v88
	v_fmac_f32 v35, v75, v88
	v_fmac_f32 v8, v92, v93
	v_fmac_f32 v32, v76, v92
	v_fmac_f32 v33, v77, v92
	v_fmac_f32 v34, v78, v92
	v_fmac_f32 v35, v79, v92
	v_permlane32_swap_b32 v8, v9
	v_permlane32_swap_b32 v32, v20
	v_permlane32_swap_b32 v33, v21
	v_permlane32_swap_b32 v34, v22
	v_permlane32_swap_b32 v35, v23
	v_add_f32 v8, v8, v9
	v_add_f32 v32, v32, v20
	v_add_f32 v33, v33, v21
	v_add_f32 v34, v34, v22
	v_add_f32 v35, v35, v23
	v_permlane16_swap_b32 v8, v9
	v_permlane16_swap_b32 v32, v20
	v_permlane16_swap_b32 v33, v21
	v_permlane16_swap_b32 v34, v22
	v_permlane16_swap_b32 v35, v23
	v_add_f32 v8, v8, v9
	v_add_f32 v32, v32, v20
	v_add_f32 v33, v33, v21
	v_add_f32 v34, v34, v22
	v_add_f32 v35, v35, v23
	v_rcp_f32 v8, v8
	s_nop 0
	v_mul_f32 v32, v32, v8
	v_mul_f32 v33, v33, v8
	v_mul_f32 v34, v34, v8
	v_mul_f32 v35, v35, v8
	v_cvt_pk_bf16_f32 v32, v32, v32
	v_cvt_pk_bf16_f32 v33, v33, v33
	v_cvt_pk_bf16_f32 v34, v34, v34
	v_cvt_pk_bf16_f32 v35, v35, v35
	s_mov_b32 exec_lo, 0xffff
	s_mov_b32 exec_hi, 0x0
	ds_write_b128 v10, v[32:35] offset:13824
	s_mov_b64 exec, -1
	s_waitcnt lgkmcnt(0)
	s_barrier
	s_endpgm
L_ch_F:
	v_lshrrev_b32 v12, 5, v0
	v_mul_u32_u24 v12, 2560, v12
	v_and_b32 v11, 31, v0
	v_lshl_add_u32 v12, v11, 4, v12
	v_and_b32 v14, 7, v0
	v_lshlrev_b32 v14, 4, v14
	v_bfe_u32 v13, v0, 4, 1
	v_lshl_add_u32 v13, v13, 7, v14
	v_lshlrev_b32 v10, 3, v0
	v_mov_b32 v11, 0
	s_lshl_b32 s52, s62, 9
	s_xor_b32 s53, s52, 512
	s_add_u32 s67, s52, 0x128000
	s_add_u32 s50, s52, 0x110000
	s_add_u32 s69, s53, 0x128000
	s_add_u32 s51, s53, 0x110000
	s_lshl_b32 s52, s62, 8
	s_xor_b32 s53, s52, 256
	s_add_u32 s56, s52, 0x140000
	s_add_u32 s96, s53, 0x140000
	s_mov_b32 s68, 0xFF00FF00
	s_mov_b32 s55, 0x000000FF
	s_bitcmp1_b32 s62, 0
	s_cselect_b32 s68, 0x00FF00FF, s68
	s_cselect_b32 s55, 0x0000FF00, s55
	buffer_load_dwordx4 v[104:107], v13, s[40:43], s50 offen sc1
	s_barrier
	s_waitcnt lgkmcnt(0)
	s_barrier
	s_waitcnt vmcnt(0)
	ds_read_b128 v[96:99], v12 offset:19456
	ds_read_b128 v[100:103], v12 offset:19968
	ds_read_b128 v[104:107], v12 offset:20480
	ds_read_b128 v[108:111], v12 offset:20992
	ds_read_b128 v[112:115], v12 offset:21504
	s_waitcnt lgkmcnt(0)
	v_add_f32 v96, v96, v100
	v_add_f32 v97, v97, v101
	v_add_f32 v98, v98, v102
	v_add_f32 v99, v99, v103
	v_add_f32 v104, v104, v108
	v_add_f32 v105, v105, v109
	v_add_f32 v106, v106, v110
	v_add_f32 v107, v107, v111
	v_add_f32 v96, v96, v104
	v_add_f32 v97, v97, v105
	v_add_f32 v98, v98, v106
	v_add_f32 v99, v99, v107
	v_add_f32 v96, v96, v112
	v_add_f32 v97, v97, v113
	v_add_f32 v98, v98, v114
	v_add_f32 v99, v99, v115
	v_permlane32_swap_b32 v96, v100
	v_permlane32_swap_b32 v97, v101
	v_permlane32_swap_b32 v98, v102
	v_permlane32_swap_b32 v99, v103
	v_add_f32 v96, v96, v100
	v_add_f32 v97, v97, v101
	v_add_f32 v98, v98, v102
	v_add_f32 v99, v99, v103
	v_mov_b32 v120, v96
	v_mov_b32 v121, v97
	v_mov_b32 v122, v98
	v_mov_b32 v123, v99
	v_lshlrev_b32 v10, 4, v0
	s_mov_b32 s52, 0xa8000
	v_mov_b32 v72, 0
	v_mov_b32 v73, 0
	v_mov_b32 v74, 0
	v_mov_b32 v75, 0
	s_mov_b32 s54, 0
Lp31:
	buffer_load_dwordx4 v[64:67], v10, s[40:43], s52 offen sc1
	buffer_load_dwordx4 v[68:71], v10, s[40:43], s52 offen offset:1024 sc1
	s_mov_b32 exec_lo, 0xffff
	s_mov_b32 exec_hi, 0x0
	buffer_load_dwordx4 v[72:75], v10, s[40:43], s52 offen offset:2048 sc1
	s_mov_b64 exec, -1
	s_waitcnt vmcnt(0)
	v_bitop3_b32 v7, v64, v65, v1 bitop3:0x7e
	v_bitop3_b32 v8, v66, v67, v1 bitop3:0x7e
	v_or_b32 v7, v7, v8
	v_bitop3_b32 v8, v68, v69, v1 bitop3:0x7e
	v_bitop3_b32 v9, v70, v71, v1 bitop3:0x7e
	v_or3_b32 v7, v7, v8, v9
	s_mov_b32 exec_lo, 0xffff
	s_mov_b32 exec_hi, 0x0
	v_bitop3_b32 v8, v72, v73, v1 bitop3:0x7e
	v_bitop3_b32 v9, v74, v75, v1 bitop3:0x7e
	v_or3_b32 v7, v7, v8, v9
	s_mov_b64 exec, -1
	v_and_b32 v7, s49, v7
	v_cmp_ne_u32 vcc, 0, v7
	s_cbranch_vccz Lok32
	s_add_u32 s54, s54, 1
	s_cmp_lt_u32 s54, 200000
	s_cbranch_scc1 Lp31
Lok32:
	s_setprio 0
	v_and_b32 v64, 0xffff0000, v64
	v_and_b32 v65, 0xffff0000, v65
	v_and_b32 v66, 0xffff0000, v66
	v_and_b32 v67, 0xffff0000, v67
	v_and_b32 v68, 0xffff0000, v68
	v_and_b32 v69, 0xffff0000, v69
	v_and_b32 v70, 0xffff0000, v70
	v_and_b32 v71, 0xffff0000, v71
	v_and_b32 v72, 0xffff0000, v72
	v_and_b32 v73, 0xffff0000, v73
	v_and_b32 v74, 0xffff0000, v74
	v_and_b32 v75, 0xffff0000, v75
	v_readfirstlane_b32 s53, v64
	v_cmp_gt_u32 vcc, 16, v0
	s_nop 0
	v_mov_b32 v7, s53
	v_cndmask_b32 v7, 0, v7, vcc
	v_subrev_f32 v64, s53, v64
	v_subrev_f32 v65, s53, v65
	v_subrev_f32 v66, s53, v66
	v_subrev_f32 v67, s53, v67
	v_subrev_f32 v68, s53, v68
	v_subrev_f32 v69, s53, v69
	v_subrev_f32 v70, s53, v70
	v_subrev_f32 v71, s53, v71
	v_sub_f32 v72, v72, v7
	v_sub_f32 v73, v73, v7
	v_sub_f32 v74, v74, v7
	v_sub_f32 v75, v75, v7
	v_add_f32 v5, v64, v65
	v_mul_f32 v6, v64, v64
	v_add_f32 v8, v66, v67
	v_mul_f32 v9, v66, v66
	v_fmac_f32 v6, v65, v65
	v_fmac_f32 v9, v67, v67
	v_add_f32 v5, v5, v68
	v_fmac_f32 v6, v68, v68
	v_add_f32 v8, v8, v69
	v_fmac_f32 v9, v69, v69
	v_add_f32 v5, v5, v70
	v_fmac_f32 v6, v70, v70
	v_add_f32 v8, v8, v71
	v_fmac_f32 v9, v71, v71
	v_add_f32 v5, v5, v72
	v_fmac_f32 v6, v72, v72
	v_add_f32 v8, v8, v73
	v_fmac_f32 v9, v73, v73
	v_add_f32 v5, v5, v74
	v_fmac_f32 v6, v74, v74
	v_add_f32 v8, v8, v75
	v_fmac_f32 v9, v75, v75
	v_add_f32 v5, v5, v8
	v_add_f32 v6, v6, v9
	s_nop 0
	v_add_f32_dpp v5, v5, v5 quad_perm:[1,0,3,2] row_mask:0xf bank_mask:0xf
	v_add_f32_dpp v6, v6, v6 quad_perm:[1,0,3,2] row_mask:0xf bank_mask:0xf
	s_nop 0
	v_add_f32_dpp v5, v5, v5 quad_perm:[2,3,0,1] row_mask:0xf bank_mask:0xf
	v_add_f32_dpp v6, v6, v6 quad_perm:[2,3,0,1] row_mask:0xf bank_mask:0xf
	s_nop 0
	v_add_f32_dpp v5, v5, v5 row_half_mirror row_mask:0xf bank_mask:0xf
	v_add_f32_dpp v6, v6, v6 row_half_mirror row_mask:0xf bank_mask:0xf
	s_nop 0
	v_add_f32_dpp v5, v5, v5 row_mirror row_mask:0xf bank_mask:0xf
	v_add_f32_dpp v6, v6, v6 row_mirror row_mask:0xf bank_mask:0xf
	v_mov_b32 v8, v5
	v_mov_b32 v9, v6
	s_nop 0
	v_permlane16_swap_b32 v8, v5
	v_permlane16_swap_b32 v9, v6
	v_add_f32 v5, v5, v8
	v_add_f32 v6, v6, v9
	v_mov_b32 v8, v5
	v_mov_b32 v9, v6
	s_nop 0
	v_permlane32_swap_b32 v8, v5
	v_permlane32_swap_b32 v9, v6
	v_add_f32 v5, v5, v8
	v_add_f32 v6, v6, v9
	s_mov_b32 s52, 0x3ae38e39
	v_mul_f32 v5, s52, v5
	v_mul_f32 v6, s52, v6
	v_fma_f32 v6, -v5, v5, v6
	v_max_f32 v6, 0, v6
	v_add_f32 v5, s53, v5
	v_add_f32 v6, 0x3727c5ac, v6
	v_rcp_f32 v6, v6
	s_setprio 3
	s_waitcnt lgkmcnt(0)
	s_barrier
	ds_read_b128 v[96:99], v12 offset:14336
	ds_read_b128 v[100:103], v12 offset:14848
	ds_read_b128 v[104:107], v12 offset:15360
	ds_read_b128 v[108:111], v12 offset:15872
	ds_read_b128 v[112:115], v12 offset:16384
	s_waitcnt lgkmcnt(0)
	v_add_f32 v96, v96, v100
	v_add_f32 v97, v97, v101
	v_add_f32 v98, v98, v102
	v_add_f32 v99, v99, v103
	v_add_f32 v104, v104, v108
	v_add_f32 v105, v105, v109
	v_add_f32 v106, v106, v110
	v_add_f32 v107, v107, v111
	v_add_f32 v96, v96, v104
	v_add_f32 v97, v97, v105
	v_add_f32 v98, v98, v106
	v_add_f32 v99, v99, v107
	v_add_f32 v96, v96, v112
	v_add_f32 v97, v97, v113
	v_add_f32 v98, v98, v114
	v_add_f32 v99, v99, v115
	v_permlane32_swap_b32 v96, v100
	v_permlane32_swap_b32 v97, v101
	v_permlane32_swap_b32 v98, v102
	v_permlane32_swap_b32 v99, v103
	v_add_f32 v96, v96, v100
	v_add_f32 v97, v97, v101
	v_add_f32 v98, v98, v102
	v_add_f32 v99, v99, v103
	v_fma_f32 v96, -v5, v120, v96
	v_fma_f32 v97, -v5, v121, v97
	v_fma_f32 v98, -v5, v122, v98
	v_fma_f32 v99, -v5, v123, v99
	v_bfi_b32 v100, s49, v1, v96
	v_bfi_b32 v101, s49, v1, v97
	v_bfi_b32 v102, s49, v1, v98
	v_bfi_b32 v103, s49, v1, v99
	s_mov_b32 exec_lo, s68
	s_mov_b32 exec_hi, 0
	buffer_store_dwordx4 v[100:103], v13, s[40:43], s69 offen
	buffer_store_dwordx4 v[100:103], v13, s[40:43], s51 offen sc1
	s_mov_b64 exec, -1
	s_mov_b32 s54, 0
Lp33:
	buffer_load_dwordx4 v[104:107], v13, s[40:43], s67 offen sc1
	s_waitcnt vmcnt(0)
	v_bitop3_b32 v7, v104, v105, v1 bitop3:0x7e
	v_bitop3_b32 v8, v106, v107, v1 bitop3:0x7e
	v_or_b32 v7, v7, v8
	v_and_b32 v7, s49, v7
	v_cmp_ne_u32 vcc, 0, v7
	s_cbranch_vccz Lok34
	s_add_u32 s54, s54, 1
	s_cmp_eq_u32 s54, 96
	s_cselect_b32 s67, s50, s67
	s_cmp_lt_u32 s54, 200000
	s_cbranch_scc1 Lp33
Lok34:
	v_add_f32 v96, v96, v104
	v_add_f32 v97, v97, v105
	v_add_f32 v98, v98, v106
	v_add_f32 v99, v99, v107
	v_permlane16_swap_b32 v96, v100
	v_permlane16_swap_b32 v97, v101
	v_permlane16_swap_b32 v98, v102
	v_permlane16_swap_b32 v99, v103
	v_mul_f32 v96, v96, v100
	v_mul_f32 v97, v97, v101
	v_mul_f32 v98, v98, v102
	v_mul_f32 v99, v99, v103
	v_mul_f32 v96, v96, v6
	v_mul_f32 v97, v97, v6
	v_mul_f32 v98, v98, v6
	v_mul_f32 v99, v99, v6
	v_cvt_pk_bf16_f32 v96, v96, v96
	v_cvt_pk_bf16_f32 v97, v97, v97
	v_cvt_pk_bf16_f32 v98, v98, v98
	v_cvt_pk_bf16_f32 v99, v99, v99
	s_mov_b32 exec_lo, s55
	s_mov_b32 exec_hi, 0
	ds_write_b128 v14, v[96:99] offset:14080
	s_mov_b64 exec, -1
	s_waitcnt lgkmcnt(0)
	s_barrier
	s_endpgm
L_codeend:
.fill 256, 4, 0xBF800000
.section .rodata,"a"
.p2align 6
.amdhsa_kernel sequential_preLN__sliding_block_cached__glu_gated_bilinear__decode_kernel
  .amdhsa_next_free_vgpr 168
  .amdhsa_next_free_sgpr 100
  .amdhsa_accum_offset 168
  .amdhsa_group_segment_fixed_size 0
  .amdhsa_kernarg_size 96
  .amdhsa_user_sgpr_count 2
  .amdhsa_user_sgpr_kernarg_segment_ptr 1
  .amdhsa_system_sgpr_workgroup_id_x 1
.end_amdhsa_kernel
```
